```python
import torch

def _softmax(x, axis=-1):
    return torch.softmax(x, dim=axis)
def _gelu(x):
    return torch.nn.functional.gelu(x, approximate="tanh")
def _silu(x):
    return torch.nn.functional.silu(x)
def _sigmoid(x):
    return torch.sigmoid(x)
def _layernorm(x, axis=-1, eps=1e-5):
    m = x.mean(dim=axis, keepdim=True)
    v = x.var(dim=axis, keepdim=True, unbiased=False)
    return (x - m) / torch.sqrt(v + eps)
def _scatter_add(tgt, idx, src, axis=0):
    return tgt.clone().index_add_(axis, idx, src)
def _segment_sum(src, seg, n):
    out = torch.zeros((n,) + src.shape[1:], dtype=src.dtype)
    return out.index_add_(0, seg, src)
def _pad(x, pw):
    flat = tuple(v for pair in reversed(pw) for v in pair)
    return torch.nn.functional.pad(x, flat)

kernel_name = 'sequential_preLN__ssm_conv_s4d__glu_gated_glu__prompt'

def setup_inputs():

    _w = (lambda a: (lambda t: t.to(torch.bfloat16) if t.is_floating_point() else t)(torch.as_tensor(a)))
    def _A_setup():
        Bsz, L, D, N = 1, 2048, 512, 128
        return {
            "u": _w((lambda *s: torch.randn(*s, dtype=torch.bfloat16) * 0.05)(Bsz, L, D)),
            "log_A_real": _w((lambda *s: torch.randn(*s, dtype=torch.bfloat16) * 6.4)(D, N) * 0.5),
            "A_imag": _w((lambda *s: torch.randn(*s, dtype=torch.bfloat16) * 0.05)(D, N) * 3.14),
            "C_real": _w((lambda *s: torch.randn(*s, dtype=torch.bfloat16) * 0.05)(D, N) / N ** 0.5),
            "C_imag": _w((lambda *s: torch.randn(*s, dtype=torch.bfloat16) * 0.05)(D, N) / N ** 0.5),
            "log_dt": _w((lambda *s: torch.randn(*s, dtype=torch.bfloat16) * 0.05)(D) * 0.5 - 4.0),
            "D_skip": _w((lambda *s: torch.randn(*s, dtype=torch.bfloat16) * 0.05)(D)),
        }
    _A_in = _A_setup()

    def _B_setup():
        B, S, D, F = 1, 2048, 512, 1792
        return {
            "x": _w((lambda *s: torch.randn(*s, dtype=torch.bfloat16) * 0.05)(B, S, D)),
            "w_gate": _w((lambda *s: torch.randn(*s, dtype=torch.bfloat16) * 0.05)(D, F)),
            "w_up": _w((lambda *s: torch.randn(*s, dtype=torch.bfloat16) * 0.05)(D, F)),
            "w_down": _w((lambda *s: torch.randn(*s, dtype=torch.bfloat16) * 0.05)(F, D)),
        }
    _B_in = _B_setup()

    return {
        "A_u": _A_in["u"],
        "A_log_A_real": _A_in["log_A_real"],
        "A_A_imag": _A_in["A_imag"],
        "A_C_real": _A_in["C_real"],
        "A_C_imag": _A_in["C_imag"],
        "A_log_dt": _A_in["log_dt"],
        "A_D_skip": _A_in["D_skip"],
        "B_x": _B_in["x"],
        "B_w_gate": _B_in["w_gate"],
        "B_w_up": _B_in["w_up"],
        "B_w_down": _B_in["w_down"],
    }

def reference(A_u, A_log_A_real, A_A_imag, A_C_real, A_C_imag, A_log_dt, A_D_skip, B_x, B_w_gate, B_w_up, B_w_down):
    def _A_ref(u, log_A_real, A_imag, C_real, C_imag, log_dt, D_skip):
        L = u.shape[1]
        dt = torch.exp(log_dt)
        A = -torch.exp(log_A_real) + 1j * A_imag
        C = (C_real + 1j * C_imag) * dt[:, None]
        pos = (lambda x, dt: x.to(dt))(torch.arange(L), log_dt.dtype)
        P = torch.exp((A * dt[:, None])[:, :, None] * pos[None, None, :])
        K = 2.0 * torch.einsum("dn,dnl->dl", C, P).real
        L2 = 2 * L
        u_t = (lambda x, *d: x.permute(*d))(u, 0, 2, 1)
        Kf = (lambda x, *a, **k: torch.fft.rfft(x.float(), *a, **k))(K, L2)
        Uf = (lambda x, *a, **k: torch.fft.rfft(x.float(), *a, **k))(u_t, L2)
        y = (lambda x, *a, **k: torch.fft.irfft(x, *a, **k).to(torch.bfloat16))(Uf * Kf[None, :, :], L2)[:, :, :L]
        y = (lambda x, *d: x.permute(*d))(y, 0, 2, 1)
        return y + u * D_skip[None, None, :]

    def _B_ref(x, w_gate, w_up, w_down):
        g = torch.einsum("bsd,df->bsf", x, w_gate)
        u = torch.einsum("bsd,df->bsf", x, w_up)
        h = _sigmoid(g) * u
        return torch.einsum("bsf,fd->bsd", h, w_down)

    x = A_u
    h = x + _A_ref(_layernorm(x, axis=-1), A_log_A_real, A_A_imag, A_C_real, A_C_imag, A_log_dt, A_D_skip)
    h2 = h + _B_ref(_layernorm(h, axis=-1), B_w_gate, B_w_up, B_w_down)
    return h2
```

```asm
; @launch kernel=k1_kernel grid=(256,1,1) block=(512,1,1) lds=142272
; @launch kernel=k3_kernel grid=(256,1,1) block=(512,1,1) lds=142336
.amdgcn_target "amdgcn-amd-amdhsa--gfx950"
.text
.globl k1_kernel
.p2align 8
.type k1_kernel,@function
k1_kernel:
  s_cmp_ge_u32 s2, 256
  s_cbranch_scc1 k1_end
  s_load_dwordx16 s[4:19], s[0:1], 0
  s_load_dwordx4 s[44:47], s[0:1], 64
  s_load_dwordx4 s[48:51], s[0:1], 80
  s_load_dwordx4 s[52:55], s[0:1], 96
  s_getpc_b64 s[30:31]
  v_lshlrev_b32 v127, 5, v0
  global_load_dword v127, v127, s[30:31]
  v_lshrrev_b32 v1, 6, v0
  v_and_b32 v0, 63, v0
  v_readfirstlane_b32 s3, v1
  s_and_b32 s20, s2, 0xf0
  s_and_b32 s21, s2, 7
  s_lshl_b32 s21, s21, 1
  s_bfe_u32 s22, s2, 0x10003
  s_add_u32 s20, s20, s21
  s_add_u32 s20, s20, s22
  s_mov_b32 s60, 0xffff0000
  s_mov_b32 s61, 0x3b000000
  s_lshr_b32 s22, s2, 2
  s_lshl_b32 s22, s22, 5
  s_and_b32 s23, s2, 3
  s_add_u32 s22, s22, s23
  s_cmp_lt_u32 s3, 4
  s_cbranch_scc1 k1_kgen
  s_sub_u32 s21, s3, 4
  s_lshl_b32 s23, s3, 2
  s_add_u32 s22, s22, s23
  s_lshl_b32 s22, s22, 10
  v_lshlrev_b32 v1, 4, v0
  v_add_u32 v2, s22, v1
  v_add_u32 v3, 4096, v2
  s_waitcnt lgkmcnt(0)
  global_load_dwordx4 v[4:7], v2, s[4:5]
  s_mul_i32 s22, s3, 2112
  s_add_u32 s22, s22, 125312
  v_lshlrev_b32 v3, 5, v0
  v_add_u32 v3, s22, v3
  v_bfe_u32 v2, v0, 2, 2
  v_mul_u32_u24 v2, 2112, v2
  v_lshrrev_b32 v8, 4, v0
  v_lshlrev_b32 v8, 5, v8
  v_and_b32 v9, 3, v0
  v_lshlrev_b32 v9, 3, v9
  v_add3_u32 v2, v2, v8, v9
  s_lshl_b32 s22, s21, 9
  s_add_u32 s22, s22, 125312
  v_add_u32 v2, s22, v2
  s_lshl_b32 s22, s2, 14
  s_lshl_b32 s23, s21, 12
  s_add_u32 s22, s22, s23
  v_add_u32 v1, s22, v1
  s_mov_b32 s8, s54
  s_mov_b32 s9, s55
  s_mov_b32 s10, 0x10000000
  s_mov_b32 s11, 0x00020000
  v_mov_b32 v120, 142208
  v_mov_b32 v121, 0
  v_mov_b32 v122, 1
  ds_write_b32 v120, v121
  v_mov_b64 v[8:9], 0
  ds_write_b64 v120, v[8:9] offset:16
  ds_write_b64 v120, v[8:9] offset:24
  s_waitcnt vmcnt(0)
  v_lshlrev_b32 v8, 16, v4
  v_and_b32 v9, s60, v4
  v_lshlrev_b32 v10, 16, v5
  v_and_b32 v11, s60, v5
  v_lshlrev_b32 v12, 16, v6
  v_and_b32 v13, s60, v6
  v_lshlrev_b32 v14, 16, v7
  v_and_b32 v15, s60, v7
  v_pk_add_f32 v[16:17], v[8:9], v[10:11]
  v_pk_add_f32 v[18:19], v[12:13], v[14:15]
  v_pk_add_f32 v[16:17], v[16:17], v[18:19]
  v_add_f32 v16, v16, v17
  s_nop 1
  v_add_f32_dpp v16, v16, v16 row_ror:8 row_mask:0xf bank_mask:0xf
  s_nop 1
  v_add_f32_dpp v16, v16, v16 row_ror:4 row_mask:0xf bank_mask:0xf
  s_nop 1
  v_add_f32_dpp v16, v16, v16 row_ror:2 row_mask:0xf bank_mask:0xf
  s_nop 1
  v_add_f32_dpp v16, v16, v16 row_ror:1 row_mask:0xf bank_mask:0xf
  s_nop 1
  v_add_f32_dpp v16, v16, v16 row_bcast:15 row_mask:0xa bank_mask:0xf
  s_nop 1
  v_add_f32_dpp v16, v16, v16 row_bcast:31 row_mask:0xc bank_mask:0xf
  s_nop 0
  v_readlane_b32 s26, v16, 63
  s_nop 1
  v_mov_b32 v20, s26
  v_mul_f32 v20, s61, v20
  v_pk_add_f32 v[22:23], v[8:9], v[20:21] op_sel_hi:[1,0] neg_lo:[0,1] neg_hi:[0,1]
  v_pk_add_f32 v[24:25], v[10:11], v[20:21] op_sel_hi:[1,0] neg_lo:[0,1] neg_hi:[0,1]
  v_pk_add_f32 v[26:27], v[12:13], v[20:21] op_sel_hi:[1,0] neg_lo:[0,1] neg_hi:[0,1]
  v_pk_add_f32 v[28:29], v[14:15], v[20:21] op_sel_hi:[1,0] neg_lo:[0,1] neg_hi:[0,1]
  v_pk_mul_f32 v[16:17], v[22:23], v[22:23]
  v_pk_fma_f32 v[16:17], v[24:25], v[24:25], v[16:17]
  v_pk_fma_f32 v[16:17], v[26:27], v[26:27], v[16:17]
  v_pk_fma_f32 v[16:17], v[28:29], v[28:29], v[16:17]
  v_cvt_pk_bf16_f32 v20, v20, v20
  v_add_f32 v16, v16, v17
  v_lshlrev_b32 v20, 16, v20
  s_nop 0
  v_add_f32_dpp v16, v16, v16 row_ror:8 row_mask:0xf bank_mask:0xf
  s_nop 1
  v_add_f32_dpp v16, v16, v16 row_ror:4 row_mask:0xf bank_mask:0xf
  s_nop 1
  v_add_f32_dpp v16, v16, v16 row_ror:2 row_mask:0xf bank_mask:0xf
  s_nop 1
  v_add_f32_dpp v16, v16, v16 row_ror:1 row_mask:0xf bank_mask:0xf
  s_nop 1
  v_add_f32_dpp v16, v16, v16 row_bcast:15 row_mask:0xa bank_mask:0xf
  s_nop 1
  v_add_f32_dpp v16, v16, v16 row_bcast:31 row_mask:0xc bank_mask:0xf
  s_nop 0
  v_readlane_b32 s27, v16, 63
  v_pk_add_f32 v[22:23], v[8:9], v[20:21] op_sel_hi:[1,0] neg_lo:[0,1] neg_hi:[0,1]
  v_pk_add_f32 v[24:25], v[10:11], v[20:21] op_sel_hi:[1,0] neg_lo:[0,1] neg_hi:[0,1]
  v_pk_add_f32 v[26:27], v[12:13], v[20:21] op_sel_hi:[1,0] neg_lo:[0,1] neg_hi:[0,1]
  v_pk_add_f32 v[28:29], v[14:15], v[20:21] op_sel_hi:[1,0] neg_lo:[0,1] neg_hi:[0,1]
  v_mov_b32 v18, s27
  v_mul_f32 v18, s61, v18
  v_cvt_pk_bf16_f32 v18, v18, v18
  v_lshlrev_b32 v18, 16, v18
  v_add_f32 v18, 0x3727c5ac, v18
  v_cvt_pk_bf16_f32 v18, v18, v18
  v_lshlrev_b32 v18, 16, v18
  v_sqrt_f32 v18, v18
  v_cvt_pk_bf16_f32 v30, v22, v23
  v_cvt_pk_bf16_f32 v31, v24, v25
  v_cvt_pk_bf16_f32 v32, v26, v27
  v_cvt_pk_bf16_f32 v33, v28, v29
  v_cvt_pk_bf16_f32 v18, v18, v18
  v_lshlrev_b32 v18, 16, v18
  v_rcp_f32 v18, v18
  v_lshlrev_b32 v22, 16, v30
  v_and_b32 v23, s60, v30
  v_lshlrev_b32 v24, 16, v31
  v_and_b32 v25, s60, v31
  v_lshlrev_b32 v26, 16, v32
  v_and_b32 v27, s60, v32
  v_lshlrev_b32 v28, 16, v33
  v_and_b32 v29, s60, v33
  v_pk_mul_f32 v[22:23], v[22:23], v[18:19] op_sel_hi:[1,0]
  v_pk_mul_f32 v[24:25], v[24:25], v[18:19] op_sel_hi:[1,0]
  v_pk_mul_f32 v[26:27], v[26:27], v[18:19] op_sel_hi:[1,0]
  v_pk_mul_f32 v[28:29], v[28:29], v[18:19] op_sel_hi:[1,0]
  v_cvt_pk_bf16_f32 v8, v22, v23
  v_mov_b32 v9, v4
  v_cvt_pk_bf16_f32 v10, v24, v25
  v_mov_b32 v11, v5
  v_cvt_pk_bf16_f32 v12, v26, v27
  v_mov_b32 v13, v6
  v_cvt_pk_bf16_f32 v14, v28, v29
  v_mov_b32 v15, v7
  ds_write_b128 v3, v[8:11]
  ds_write_b128 v3, v[12:15] offset:16
  s_waitcnt lgkmcnt(0)
  s_barrier
  ds_read_b64_tr_b16 v[8:9], v2 offset:0
  ds_read_b64_tr_b16 v[10:11], v2 offset:8448
  ds_read_b64_tr_b16 v[12:13], v2 offset:128
  ds_read_b64_tr_b16 v[14:15], v2 offset:8576
  ds_read_b64_tr_b16 v[16:17], v2 offset:256
  ds_read_b64_tr_b16 v[18:19], v2 offset:8704
  ds_read_b64_tr_b16 v[20:21], v2 offset:384
  ds_read_b64_tr_b16 v[22:23], v2 offset:8832
  s_waitcnt lgkmcnt(6)
  global_store_dwordx4 v1, v[8:11], s[54:55] offset:0 sc1
  s_waitcnt lgkmcnt(4)
  global_store_dwordx4 v1, v[12:15], s[54:55] offset:1024 sc1
  s_waitcnt lgkmcnt(2)
  global_store_dwordx4 v1, v[16:19], s[54:55] offset:2048 sc1
  s_waitcnt lgkmcnt(0)
  global_store_dwordx4 v1, v[20:23], s[54:55] offset:3072 sc1
  v_lshrrev_b32 v90, 2, v0
  v_lshlrev_b32 v90, 14, v90
  v_lshrrev_b32 v91, 4, v0
  v_xor_b32 v91, v91, v0
  v_and_b32 v91, 3, v91
  v_lshlrev_b32 v91, 4, v91
  s_lshl_b32 s23, s20, 6
  v_add3_u32 v90, v90, v91, s23
  v_mul_u32_u24 v91, 64, v0
  s_and_b32 s22, s2, 0
  s_mul_i32 s22, s22, 16384
  s_mul_i32 s30, s21, 4096
  s_add_u32 s30, s30, s22
  s_add_u32 s30, s30, 25690112
  s_lshl_b32 s29, s21, 20
  s_lshl_b32 s22, s21, 12
  s_add_u32 m0, s22, 71680
  v_lshl_add_u32 v123, s21, 2, v120
  v_and_b32 v92, 1, v0
  v_lshlrev_b32 v92, 7, v92
  s_cmp_eq_u32 s3, 7
  s_cbranch_scc1 k1_w7
  s_cmp_eq_u32 s3, 6
  s_cbranch_scc1 k1_w6
  s_and_b32 s20, s2, 7
  s_lshr_b32 s21, s2, 3
  s_cmp_eq_u32 s3, 5
  s_cbranch_scc1 k1_w5
  v_lshrrev_b32 v2, 4, v0
  v_lshlrev_b32 v2, 10, v2
  v_bfe_u32 v3, v0, 2, 2
  v_lshl_add_u32 v2, v3, 7, v2
  v_and_b32 v3, 3, v0
  v_lshl_add_u32 v2, v3, 3, v2
  v_add_u32 v2, 100608, v2
  v_cmp_gt_u32 s[26:27], 2, v3
  v_lshlrev_b32 v3, 4, v0
  s_mul_i32 s22, s20, 458752
  s_lshl_b32 s23, s21, 13
  s_add_u32 s22, s22, s23
  s_add_u32 s22, s22, 8388608
  s_add_u32 s23, s22, 4096
  v_lshlrev_b32 v4, 2, v0
  s_mul_i32 s24, s20, 14336
  s_lshl_b32 s25, s21, 9
  s_add_u32 s24, s24, s25
  s_add_u32 s24, s24, 12582912
  s_mov_b32 s25, 0x3f803f80
  global_load_dword v93, v92, s[52:53] sc1
  s_waitcnt vmcnt(1)
  ds_add_u32 v120, v122
  v_mov_b64 v[8:9], 0
  v_mov_b64 v[10:11], 0
  v_mov_b64 v[12:13], 0
  v_mov_b64 v[14:15], 0
  s_mov_b32 s37, 0x40000
  s_branch k1_kernel_sc3
k1_kernel_sp1:
  global_load_dword v93, v92, s[52:53] sc1
k1_kernel_sc3:
  s_waitcnt vmcnt(0)
  v_cmp_eq_u32 vcc, 0, v93
  s_cbranch_vccz k1_kernel_sd2
  s_sleep 1
  s_sub_u32 s37, s37, 1
  s_cmp_lg_u32 s37, 0
  s_cbranch_scc1 k1_kernel_sp1
k1_kernel_sd2:
  buffer_load_dword v93, v91, s[8:11], s30 offen sc1
  s_mov_b32 s37, 0x40000
  s_branch k1_kernel_sc6
k1_kernel_sp4:
  buffer_load_dword v93, v91, s[8:11], s30 offen sc1
k1_kernel_sc6:
  s_waitcnt vmcnt(0)
  v_cmp_eq_u32 vcc, 0, v93
  s_cbranch_vccz k1_kernel_sd5
  s_sleep 1
  s_sub_u32 s37, s37, 1
  s_cmp_lg_u32 s37, 0
  s_cbranch_scc1 k1_kernel_sp4
k1_kernel_sd5:
  s_barrier
  buffer_load_dwordx4 v90, s[8:11], s29 offen sc1 lds
  s_add_u32 m0, m0, 1024
  s_add_u32 s29, s29, 262144
  buffer_load_dwordx4 v90, s[8:11], s29 offen sc1 lds
  s_add_u32 m0, m0, 1024
  s_add_u32 s29, s29, 262144
  buffer_load_dwordx4 v90, s[8:11], s29 offen sc1 lds
  s_add_u32 m0, m0, 1024
  s_add_u32 s29, s29, 262144
  buffer_load_dwordx4 v90, s[8:11], s29 offen sc1 lds
  s_barrier
  s_waitcnt vmcnt(0)
  ds_write_b32 v123, v122 offset:16
  s_cmp_ge_u32 s2, 224
  s_cbranch_scc1 k1_end
  ds_read_b64_tr_b16 v[16:17], v2 offset:0
  ds_read_b64_tr_b16 v[18:19], v2 offset:512
  ds_read_b64_tr_b16 v[20:21], v2 offset:8256
  ds_read_b64_tr_b16 v[22:23], v2 offset:8768
  ds_read_b64_tr_b16 v[24:25], v2 offset:32
  ds_read_b64_tr_b16 v[26:27], v2 offset:544
  ds_read_b64_tr_b16 v[28:29], v2 offset:8288
  ds_read_b64_tr_b16 v[30:31], v2 offset:8800
  ds_read_b64_tr_b16 v[32:33], v2 offset:64
  ds_read_b64_tr_b16 v[34:35], v2 offset:576
  ds_read_b64_tr_b16 v[36:37], v2 offset:8320
  ds_read_b64_tr_b16 v[38:39], v2 offset:8832
  ds_read_b64_tr_b16 v[40:41], v2 offset:96
  ds_read_b64_tr_b16 v[42:43], v2 offset:608
  ds_read_b64_tr_b16 v[44:45], v2 offset:8352
  ds_read_b64_tr_b16 v[46:47], v2 offset:8864
  s_mov_b64 vcc, s[26:27]
  s_waitcnt lgkmcnt(12)
  v_cndmask_b32_dpp v48, v20, v16, vcc quad_perm:[0,1,0,1] row_mask:0xf bank_mask:0xf
  v_cndmask_b32_dpp v49, v21, v17, vcc quad_perm:[0,1,0,1] row_mask:0xf bank_mask:0xf
  v_cndmask_b32_dpp v50, v22, v18, vcc quad_perm:[0,1,0,1] row_mask:0xf bank_mask:0xf
  v_cndmask_b32_dpp v51, v23, v19, vcc quad_perm:[0,1,0,1] row_mask:0xf bank_mask:0xf
  s_waitcnt lgkmcnt(8)
  v_cndmask_b32_dpp v56, v28, v24, vcc quad_perm:[0,1,0,1] row_mask:0xf bank_mask:0xf
  v_cndmask_b32_dpp v57, v29, v25, vcc quad_perm:[0,1,0,1] row_mask:0xf bank_mask:0xf
  v_cndmask_b32_dpp v58, v30, v26, vcc quad_perm:[0,1,0,1] row_mask:0xf bank_mask:0xf
  v_cndmask_b32_dpp v59, v31, v27, vcc quad_perm:[0,1,0,1] row_mask:0xf bank_mask:0xf
  s_waitcnt lgkmcnt(4)
  v_cndmask_b32_dpp v64, v36, v32, vcc quad_perm:[0,1,0,1] row_mask:0xf bank_mask:0xf
  v_cndmask_b32_dpp v65, v37, v33, vcc quad_perm:[0,1,0,1] row_mask:0xf bank_mask:0xf
  v_cndmask_b32_dpp v66, v38, v34, vcc quad_perm:[0,1,0,1] row_mask:0xf bank_mask:0xf
  v_cndmask_b32_dpp v67, v39, v35, vcc quad_perm:[0,1,0,1] row_mask:0xf bank_mask:0xf
  s_waitcnt lgkmcnt(0)
  v_cndmask_b32_dpp v72, v44, v40, vcc quad_perm:[0,1,0,1] row_mask:0xf bank_mask:0xf
  v_cndmask_b32_dpp v73, v45, v41, vcc quad_perm:[0,1,0,1] row_mask:0xf bank_mask:0xf
  v_cndmask_b32_dpp v74, v46, v42, vcc quad_perm:[0,1,0,1] row_mask:0xf bank_mask:0xf
  v_cndmask_b32_dpp v75, v47, v43, vcc quad_perm:[0,1,0,1] row_mask:0xf bank_mask:0xf
  s_not_b64 vcc, s[26:27]
  v_cndmask_b32_dpp v52, v16, v20, vcc quad_perm:[2,3,2,3] row_mask:0xf bank_mask:0xf
  v_cndmask_b32_dpp v53, v17, v21, vcc quad_perm:[2,3,2,3] row_mask:0xf bank_mask:0xf
  v_cndmask_b32_dpp v54, v18, v22, vcc quad_perm:[2,3,2,3] row_mask:0xf bank_mask:0xf
  v_cndmask_b32_dpp v55, v19, v23, vcc quad_perm:[2,3,2,3] row_mask:0xf bank_mask:0xf
  v_cndmask_b32_dpp v60, v24, v28, vcc quad_perm:[2,3,2,3] row_mask:0xf bank_mask:0xf
  v_cndmask_b32_dpp v61, v25, v29, vcc quad_perm:[2,3,2,3] row_mask:0xf bank_mask:0xf
  v_cndmask_b32_dpp v62, v26, v30, vcc quad_perm:[2,3,2,3] row_mask:0xf bank_mask:0xf
  v_cndmask_b32_dpp v63, v27, v31, vcc quad_perm:[2,3,2,3] row_mask:0xf bank_mask:0xf
  v_cndmask_b32_dpp v68, v32, v36, vcc quad_perm:[2,3,2,3] row_mask:0xf bank_mask:0xf
  v_cndmask_b32_dpp v69, v33, v37, vcc quad_perm:[2,3,2,3] row_mask:0xf bank_mask:0xf
  v_cndmask_b32_dpp v70, v34, v38, vcc quad_perm:[2,3,2,3] row_mask:0xf bank_mask:0xf
  v_cndmask_b32_dpp v71, v35, v39, vcc quad_perm:[2,3,2,3] row_mask:0xf bank_mask:0xf
  v_cndmask_b32_dpp v76, v40, v44, vcc quad_perm:[2,3,2,3] row_mask:0xf bank_mask:0xf
  v_cndmask_b32_dpp v77, v41, v45, vcc quad_perm:[2,3,2,3] row_mask:0xf bank_mask:0xf
  v_cndmask_b32_dpp v78, v42, v46, vcc quad_perm:[2,3,2,3] row_mask:0xf bank_mask:0xf
  v_cndmask_b32_dpp v79, v43, v47, vcc quad_perm:[2,3,2,3] row_mask:0xf bank_mask:0xf
  v_dot2c_f32_bf16 v8, s25, v48
  v_dot2c_f32_bf16 v9, s25, v52
  v_dot2c_f32_bf16 v10, s25, v56
  v_dot2c_f32_bf16 v11, s25, v60
  v_dot2c_f32_bf16 v12, s25, v64
  v_dot2c_f32_bf16 v13, s25, v68
  v_dot2c_f32_bf16 v14, s25, v72
  v_dot2c_f32_bf16 v15, s25, v76
  v_dot2c_f32_bf16 v8, s25, v49
  v_dot2c_f32_bf16 v9, s25, v53
  v_dot2c_f32_bf16 v10, s25, v57
  v_dot2c_f32_bf16 v11, s25, v61
  v_dot2c_f32_bf16 v12, s25, v65
  v_dot2c_f32_bf16 v13, s25, v69
  v_dot2c_f32_bf16 v14, s25, v73
  v_dot2c_f32_bf16 v15, s25, v77
  v_dot2c_f32_bf16 v8, s25, v50
  v_dot2c_f32_bf16 v9, s25, v54
  v_dot2c_f32_bf16 v10, s25, v58
  v_dot2c_f32_bf16 v11, s25, v62
  v_dot2c_f32_bf16 v12, s25, v66
  v_dot2c_f32_bf16 v13, s25, v70
  v_dot2c_f32_bf16 v14, s25, v74
  v_dot2c_f32_bf16 v15, s25, v78
  v_dot2c_f32_bf16 v8, s25, v51
  v_dot2c_f32_bf16 v9, s25, v55
  v_dot2c_f32_bf16 v10, s25, v59
  v_dot2c_f32_bf16 v11, s25, v63
  v_dot2c_f32_bf16 v12, s25, v67
  v_dot2c_f32_bf16 v13, s25, v71
  v_dot2c_f32_bf16 v14, s25, v75
  v_dot2c_f32_bf16 v15, s25, v79
  ds_read_b64_tr_b16 v[16:17], v2 offset:4096
  ds_read_b64_tr_b16 v[18:19], v2 offset:4608
  ds_read_b64_tr_b16 v[20:21], v2 offset:12352
  ds_read_b64_tr_b16 v[22:23], v2 offset:12864
  ds_read_b64_tr_b16 v[24:25], v2 offset:4128
  ds_read_b64_tr_b16 v[26:27], v2 offset:4640
  ds_read_b64_tr_b16 v[28:29], v2 offset:12384
  ds_read_b64_tr_b16 v[30:31], v2 offset:12896
  ds_read_b64_tr_b16 v[32:33], v2 offset:4160
  ds_read_b64_tr_b16 v[34:35], v2 offset:4672
  ds_read_b64_tr_b16 v[36:37], v2 offset:12416
  ds_read_b64_tr_b16 v[38:39], v2 offset:12928
  ds_read_b64_tr_b16 v[40:41], v2 offset:4192
  ds_read_b64_tr_b16 v[42:43], v2 offset:4704
  ds_read_b64_tr_b16 v[44:45], v2 offset:12448
  ds_read_b64_tr_b16 v[46:47], v2 offset:12960
  s_mov_b64 vcc, s[26:27]
  s_waitcnt lgkmcnt(12)
  v_cndmask_b32_dpp v80, v20, v16, vcc quad_perm:[0,1,0,1] row_mask:0xf bank_mask:0xf
  v_cndmask_b32_dpp v81, v21, v17, vcc quad_perm:[0,1,0,1] row_mask:0xf bank_mask:0xf
  v_cndmask_b32_dpp v82, v22, v18, vcc quad_perm:[0,1,0,1] row_mask:0xf bank_mask:0xf
  v_cndmask_b32_dpp v83, v23, v19, vcc quad_perm:[0,1,0,1] row_mask:0xf bank_mask:0xf
  s_waitcnt lgkmcnt(8)
  v_cndmask_b32_dpp v88, v28, v24, vcc quad_perm:[0,1,0,1] row_mask:0xf bank_mask:0xf
  v_cndmask_b32_dpp v89, v29, v25, vcc quad_perm:[0,1,0,1] row_mask:0xf bank_mask:0xf
  v_cndmask_b32_dpp v90, v30, v26, vcc quad_perm:[0,1,0,1] row_mask:0xf bank_mask:0xf
  v_cndmask_b32_dpp v91, v31, v27, vcc quad_perm:[0,1,0,1] row_mask:0xf bank_mask:0xf
  s_waitcnt lgkmcnt(4)
  v_cndmask_b32_dpp v96, v36, v32, vcc quad_perm:[0,1,0,1] row_mask:0xf bank_mask:0xf
  v_cndmask_b32_dpp v97, v37, v33, vcc quad_perm:[0,1,0,1] row_mask:0xf bank_mask:0xf
  v_cndmask_b32_dpp v98, v38, v34, vcc quad_perm:[0,1,0,1] row_mask:0xf bank_mask:0xf
  v_cndmask_b32_dpp v99, v39, v35, vcc quad_perm:[0,1,0,1] row_mask:0xf bank_mask:0xf
  s_waitcnt lgkmcnt(0)
  v_cndmask_b32_dpp v104, v44, v40, vcc quad_perm:[0,1,0,1] row_mask:0xf bank_mask:0xf
  v_cndmask_b32_dpp v105, v45, v41, vcc quad_perm:[0,1,0,1] row_mask:0xf bank_mask:0xf
  v_cndmask_b32_dpp v106, v46, v42, vcc quad_perm:[0,1,0,1] row_mask:0xf bank_mask:0xf
  v_cndmask_b32_dpp v107, v47, v43, vcc quad_perm:[0,1,0,1] row_mask:0xf bank_mask:0xf
  s_not_b64 vcc, s[26:27]
  v_cndmask_b32_dpp v84, v16, v20, vcc quad_perm:[2,3,2,3] row_mask:0xf bank_mask:0xf
  v_cndmask_b32_dpp v85, v17, v21, vcc quad_perm:[2,3,2,3] row_mask:0xf bank_mask:0xf
  v_cndmask_b32_dpp v86, v18, v22, vcc quad_perm:[2,3,2,3] row_mask:0xf bank_mask:0xf
  v_cndmask_b32_dpp v87, v19, v23, vcc quad_perm:[2,3,2,3] row_mask:0xf bank_mask:0xf
  v_cndmask_b32_dpp v92, v24, v28, vcc quad_perm:[2,3,2,3] row_mask:0xf bank_mask:0xf
  v_cndmask_b32_dpp v93, v25, v29, vcc quad_perm:[2,3,2,3] row_mask:0xf bank_mask:0xf
  v_cndmask_b32_dpp v94, v26, v30, vcc quad_perm:[2,3,2,3] row_mask:0xf bank_mask:0xf
  v_cndmask_b32_dpp v95, v27, v31, vcc quad_perm:[2,3,2,3] row_mask:0xf bank_mask:0xf
  v_cndmask_b32_dpp v100, v32, v36, vcc quad_perm:[2,3,2,3] row_mask:0xf bank_mask:0xf
  v_cndmask_b32_dpp v101, v33, v37, vcc quad_perm:[2,3,2,3] row_mask:0xf bank_mask:0xf
  v_cndmask_b32_dpp v102, v34, v38, vcc quad_perm:[2,3,2,3] row_mask:0xf bank_mask:0xf
  v_cndmask_b32_dpp v103, v35, v39, vcc quad_perm:[2,3,2,3] row_mask:0xf bank_mask:0xf
  v_cndmask_b32_dpp v108, v40, v44, vcc quad_perm:[2,3,2,3] row_mask:0xf bank_mask:0xf
  v_cndmask_b32_dpp v109, v41, v45, vcc quad_perm:[2,3,2,3] row_mask:0xf bank_mask:0xf
  v_cndmask_b32_dpp v110, v42, v46, vcc quad_perm:[2,3,2,3] row_mask:0xf bank_mask:0xf
  v_cndmask_b32_dpp v111, v43, v47, vcc quad_perm:[2,3,2,3] row_mask:0xf bank_mask:0xf
  v_dot2c_f32_bf16 v8, s25, v80
  v_dot2c_f32_bf16 v9, s25, v84
  v_dot2c_f32_bf16 v10, s25, v88
  v_dot2c_f32_bf16 v11, s25, v92
  v_dot2c_f32_bf16 v12, s25, v96
  v_dot2c_f32_bf16 v13, s25, v100
  v_dot2c_f32_bf16 v14, s25, v104
  v_dot2c_f32_bf16 v15, s25, v108
  v_dot2c_f32_bf16 v8, s25, v81
  v_dot2c_f32_bf16 v9, s25, v85
  v_dot2c_f32_bf16 v10, s25, v89
  v_dot2c_f32_bf16 v11, s25, v93
  v_dot2c_f32_bf16 v12, s25, v97
  v_dot2c_f32_bf16 v13, s25, v101
  v_dot2c_f32_bf16 v14, s25, v105
  v_dot2c_f32_bf16 v15, s25, v109
  v_dot2c_f32_bf16 v8, s25, v82
  v_dot2c_f32_bf16 v9, s25, v86
  v_dot2c_f32_bf16 v10, s25, v90
  v_dot2c_f32_bf16 v11, s25, v94
  v_dot2c_f32_bf16 v12, s25, v98
  v_dot2c_f32_bf16 v13, s25, v102
  v_dot2c_f32_bf16 v14, s25, v106
  v_dot2c_f32_bf16 v15, s25, v110
  v_dot2c_f32_bf16 v8, s25, v83
  v_dot2c_f32_bf16 v9, s25, v87
  v_dot2c_f32_bf16 v10, s25, v91
  v_dot2c_f32_bf16 v11, s25, v95
  v_dot2c_f32_bf16 v12, s25, v99
  v_dot2c_f32_bf16 v13, s25, v103
  v_dot2c_f32_bf16 v14, s25, v107
  v_dot2c_f32_bf16 v15, s25, v111
  v_permlane16_swap_b32 v8, v9
  v_permlane16_swap_b32 v10, v11
  v_permlane16_swap_b32 v12, v13
  v_permlane16_swap_b32 v14, v15
  v_add_f32 v8, v8, v9
  v_add_f32 v10, v10, v11
  v_add_f32 v12, v12, v13
  v_add_f32 v14, v14, v15
  v_permlane32_swap_b32 v8, v10
  s_nop 0
  v_permlane32_swap_b32 v12, v14
  v_add_f32 v8, v8, v10
  v_add_f32 v12, v12, v14
  ds_read_b32 v5, v120 offset:20
  s_mov_b32 s37, 0x40000
  s_branch k1_kernel_sc9
k1_kernel_sp7:
  ds_read_b32 v5, v120 offset:20
k1_kernel_sc9:
  s_waitcnt lgkmcnt(0)
  v_cmp_eq_u32 vcc, 0, v5
  s_cbranch_vccz k1_kernel_sd8
  s_sleep 2
  s_sub_u32 s37, s37, 1
  s_cmp_lg_u32 s37, 0
  s_cbranch_scc1 k1_kernel_sp7
k1_kernel_sd8:
  buffer_store_dwordx4 v[48:51], v3, s[8:11], s22 offen offset:0 sc1
  buffer_store_dwordx4 v[56:59], v3, s[8:11], s22 offen offset:2048 sc1
  buffer_store_dwordx4 v[64:67], v3, s[8:11], s23 offen offset:0 sc1
  buffer_store_dwordx4 v[72:75], v3, s[8:11], s23 offen offset:2048 sc1
  buffer_store_dwordx4 v[52:55], v3, s[8:11], s22 offen offset:1024 sc1
  buffer_store_dwordx4 v[60:63], v3, s[8:11], s22 offen offset:3072 sc1
  buffer_store_dwordx4 v[68:71], v3, s[8:11], s23 offen offset:1024 sc1
  buffer_store_dwordx4 v[76:79], v3, s[8:11], s23 offen offset:3072 sc1
  s_add_u32 s22, s22, 229376
  s_add_u32 s23, s23, 229376
  buffer_store_dwordx4 v[80:83], v3, s[8:11], s22 offen offset:0 sc1
  buffer_store_dwordx4 v[88:91], v3, s[8:11], s22 offen offset:2048 sc1
  buffer_store_dwordx4 v[96:99], v3, s[8:11], s23 offen offset:0 sc1
  buffer_store_dwordx4 v[104:107], v3, s[8:11], s23 offen offset:2048 sc1
  buffer_store_dwordx4 v[84:87], v3, s[8:11], s22 offen offset:1024 sc1
  buffer_store_dwordx4 v[92:95], v3, s[8:11], s22 offen offset:3072 sc1
  buffer_store_dwordx4 v[100:103], v3, s[8:11], s23 offen offset:1024 sc1
  buffer_store_dwordx4 v[108:111], v3, s[8:11], s23 offen offset:3072 sc1
  s_add_u32 s22, s22, 229376
  s_add_u32 s23, s23, 229376
  buffer_store_dword v8, v4, s[8:11], s24 offen sc1
  buffer_store_dword v12, v4, s[8:11], s24 offen offset:256 sc1
  s_barrier
  s_endpgm
k1_w5:
  v_lshrrev_b32 v2, 5, v0
  v_lshlrev_b32 v2, 8, v2
  v_bfe_u32 v3, v0, 2, 1
  v_lshl_add_u32 v2, v3, 7, v2
  v_bfe_u32 v3, v0, 3, 1
  v_lshl_add_u32 v2, v3, 9, v2
  v_bfe_u32 v3, v0, 4, 1
  v_lshl_add_u32 v2, v3, 5, v2
  v_and_b32 v3, 3, v0
  v_lshl_add_u32 v2, v3, 3, v2
  v_add_u32 v2, 117120, v2
  v_lshlrev_b32 v3, 4, v0
  s_mul_i32 s22, s20, 229376
  s_lshl_b32 s23, s21, 12
  s_add_u32 s22, s22, s23
  s_add_u32 s22, s22, 22020096
  s_add_u32 s23, s22, 114688
  s_waitcnt vmcnt(0)
  ds_add_u32 v120, v122
  s_barrier
  buffer_load_dword v93, v91, s[8:11], s30 offen sc1
  s_barrier
  s_mov_b32 s37, 0x40000
  s_branch k1_kernel_sc12
k1_kernel_sp10:
  buffer_load_dword v93, v91, s[8:11], s30 offen sc1
k1_kernel_sc12:
  s_waitcnt vmcnt(0)
  v_cmp_eq_u32 vcc, 0, v93
  s_cbranch_vccz k1_kernel_sd11
  s_sleep 1
  s_sub_u32 s37, s37, 1
  s_cmp_lg_u32 s37, 0
  s_cbranch_scc1 k1_kernel_sp10
k1_kernel_sd11:
  buffer_load_dwordx4 v90, s[8:11], s29 offen sc1 lds
  s_add_u32 m0, m0, 1024
  s_add_u32 s29, s29, 262144
  buffer_load_dwordx4 v90, s[8:11], s29 offen sc1 lds
  s_add_u32 m0, m0, 1024
  s_add_u32 s29, s29, 262144
  buffer_load_dwordx4 v90, s[8:11], s29 offen sc1 lds
  s_add_u32 m0, m0, 1024
  s_add_u32 s29, s29, 262144
  buffer_load_dwordx4 v90, s[8:11], s29 offen sc1 lds
  s_waitcnt vmcnt(0)
  ds_write_b32 v123, v122 offset:16
  s_cmp_ge_u32 s2, 224
  s_cbranch_scc1 k1_end
  ds_read_b64_tr_b16 v[16:17], v2 offset:0
  ds_read_b64_tr_b16 v[18:19], v2 offset:1024
  ds_read_b64_tr_b16 v[20:21], v2 offset:64
  ds_read_b64_tr_b16 v[22:23], v2 offset:1088
  s_waitcnt lgkmcnt(2)
  s_waitcnt lgkmcnt(0)
  ds_read_b64_tr_b16 v[24:25], v2 offset:2048
  ds_read_b64_tr_b16 v[26:27], v2 offset:3072
  ds_read_b64_tr_b16 v[28:29], v2 offset:2112
  ds_read_b64_tr_b16 v[30:31], v2 offset:3136
  s_waitcnt lgkmcnt(2)
  s_waitcnt lgkmcnt(0)
  ds_read_b64_tr_b16 v[32:33], v2 offset:4096
  ds_read_b64_tr_b16 v[34:35], v2 offset:5120
  ds_read_b64_tr_b16 v[36:37], v2 offset:4160
  ds_read_b64_tr_b16 v[38:39], v2 offset:5184
  s_waitcnt lgkmcnt(2)
  s_waitcnt lgkmcnt(0)
  ds_read_b64_tr_b16 v[40:41], v2 offset:6144
  ds_read_b64_tr_b16 v[42:43], v2 offset:7168
  ds_read_b64_tr_b16 v[44:45], v2 offset:6208
  ds_read_b64_tr_b16 v[46:47], v2 offset:7232
  s_waitcnt lgkmcnt(2)
  s_waitcnt lgkmcnt(0)
  ds_read_b32 v5, v120 offset:20
  s_mov_b32 s37, 0x40000
  s_branch k1_kernel_sc15
k1_kernel_sp13:
  ds_read_b32 v5, v120 offset:20
k1_kernel_sc15:
  s_waitcnt lgkmcnt(0)
  v_cmp_eq_u32 vcc, 0, v5
  s_cbranch_vccz k1_kernel_sd14
  s_sleep 2
  s_sub_u32 s37, s37, 1
  s_cmp_lg_u32 s37, 0
  s_cbranch_scc1 k1_kernel_sp13
k1_kernel_sd14:
  buffer_store_dwordx4 v[16:19], v3, s[8:11], s22 offen offset:0 sc1
  buffer_store_dwordx4 v[20:23], v3, s[8:11], s23 offen offset:0 sc1
  buffer_store_dwordx4 v[24:27], v3, s[8:11], s22 offen offset:1024 sc1
  buffer_store_dwordx4 v[28:31], v3, s[8:11], s23 offen offset:1024 sc1
  buffer_store_dwordx4 v[32:35], v3, s[8:11], s22 offen offset:2048 sc1
  buffer_store_dwordx4 v[36:39], v3, s[8:11], s23 offen offset:2048 sc1
  buffer_store_dwordx4 v[40:43], v3, s[8:11], s22 offen offset:3072 sc1
  buffer_store_dwordx4 v[44:47], v3, s[8:11], s23 offen offset:3072 sc1
  s_barrier
  s_endpgm
k1_w7:
  v_and_b32 v4, 1, v0
  v_lshlrev_b32 v4, 7, v4
  global_load_dword v5, v4, s[52:53] sc1
  v_lshrrev_b32 v6, 2, v0
  v_mul_u32_u24 v6, 16384, v6
  v_and_b32 v7, 3, v0
  v_lshl_add_u32 v6, v7, 4, v6
  s_mul_i32 s22, s2, 64
  s_add_u32 s22, s22, 25690112
  v_mov_b32 v124, 1
  v_mov_b32 v125, 1
  v_mov_b32 v126, 1
  v_mov_b32 v127, 1
  s_mov_b32 s37, 0x40000
  s_branch k1_kernel_sc18
k1_kernel_sp16:
  global_load_dword v5, v4, s[52:53] sc1
k1_kernel_sc18:
  s_waitcnt vmcnt(0)
  v_cmp_eq_u32 vcc, 0, v5
  s_cbranch_vccz k1_kernel_sd17
  s_sleep 1
  s_sub_u32 s37, s37, 1
  s_cmp_lg_u32 s37, 0
  s_cbranch_scc1 k1_kernel_sp16
k1_kernel_sd17:
  ds_read_b32 v5, v120
  s_mov_b32 s37, 0x40000
  s_branch k1_kernel_sc21
k1_kernel_sp19:
  ds_read_b32 v5, v120
k1_kernel_sc21:
  s_waitcnt lgkmcnt(0)
  v_cmp_ne_u32 vcc, 192, v5
  s_cbranch_vccz k1_kernel_sd20
  s_sub_u32 s37, s37, 1
  s_cmp_lg_u32 s37, 0
  s_cbranch_scc1 k1_kernel_sp19
k1_kernel_sd20:
  s_lshr_b64 exec, exec, 60
  buffer_store_dwordx4 v[124:127], v6, s[8:11], s22 offen sc1
  s_mov_b64 exec, -1
  s_cmp_lt_u32 s2, 224
  s_cbranch_scc1 k1_w7e
  v_lshlrev_b32 v1, 2, v0
  s_mul_i32 s20, s2, 4352
  s_add_u32 s20, s20, 24190976
  s_lshl_b32 s21, s2, 12
  s_add_u32 s21, s21, 24510464
  v_lshlrev_b32 v3, 6, v0
  buffer_store_dword v121, v1, s[8:11], s20 offen sc1
  buffer_store_dword v121, v1, s[8:11], s21 offen sc1
  buffer_store_dword v121, v3, s[8:11], s21 offen sc1
k1_w7e:
  s_barrier
  buffer_load_dword v93, v91, s[8:11], s30 offen sc1
  s_barrier
  s_mov_b32 s37, 0x40000
  s_branch k1_kernel_sc24
k1_kernel_sp22:
  buffer_load_dword v93, v91, s[8:11], s30 offen sc1
k1_kernel_sc24:
  s_waitcnt vmcnt(0)
  v_cmp_eq_u32 vcc, 0, v93
  s_cbranch_vccz k1_kernel_sd23
  s_sleep 1
  s_sub_u32 s37, s37, 1
  s_cmp_lg_u32 s37, 0
  s_cbranch_scc1 k1_kernel_sp22
k1_kernel_sd23:
  buffer_load_dwordx4 v90, s[8:11], s29 offen sc1 lds
  s_add_u32 m0, m0, 1024
  s_add_u32 s29, s29, 262144
  buffer_load_dwordx4 v90, s[8:11], s29 offen sc1 lds
  s_add_u32 m0, m0, 1024
  s_add_u32 s29, s29, 262144
  buffer_load_dwordx4 v90, s[8:11], s29 offen sc1 lds
  s_add_u32 m0, m0, 1024
  s_add_u32 s29, s29, 262144
  buffer_load_dwordx4 v90, s[8:11], s29 offen sc1 lds
  s_waitcnt vmcnt(0)
  ds_write_b32 v123, v122 offset:16
  s_endpgm
k1_w6:
  s_waitcnt vmcnt(0)
  ds_add_u32 v120, v122
  s_getpc_b64 s[34:35]
k1_kernel_pc25:
  s_add_u32 s34, s34, k3_kernel-k1_kernel_pc25
  s_addc_u32 s35, s35, (k3_kernel-k1_kernel_pc25)>>32
  v_lshlrev_b32 v100, 7, v0
  v_min_u32 v101, k3_end-k3_kernel-4, v100
  global_load_dword v102, v101, s[34:35]
  v_add_u32 v100, 0x2000, v100
  v_min_u32 v101, k3_end-k3_kernel-4, v100
  global_load_dword v103, v101, s[34:35]
  s_barrier
  buffer_load_dword v93, v91, s[8:11], s30 offen sc1
  s_barrier
  s_mov_b32 s37, 0x40000
  s_branch k1_kernel_sc28
k1_kernel_sp26:
  buffer_load_dword v93, v91, s[8:11], s30 offen sc1
k1_kernel_sc28:
  s_waitcnt vmcnt(0)
  v_cmp_eq_u32 vcc, 0, v93
  s_cbranch_vccz k1_kernel_sd27
  s_sleep 1
  s_sub_u32 s37, s37, 1
  s_cmp_lg_u32 s37, 0
  s_cbranch_scc1 k1_kernel_sp26
k1_kernel_sd27:
  buffer_load_dwordx4 v90, s[8:11], s29 offen sc1 lds
  s_add_u32 m0, m0, 1024
  s_add_u32 s29, s29, 262144
  buffer_load_dwordx4 v90, s[8:11], s29 offen sc1 lds
  s_add_u32 m0, m0, 1024
  s_add_u32 s29, s29, 262144
  buffer_load_dwordx4 v90, s[8:11], s29 offen sc1 lds
  s_add_u32 m0, m0, 1024
  s_add_u32 s29, s29, 262144
  buffer_load_dwordx4 v90, s[8:11], s29 offen sc1 lds
  s_waitcnt vmcnt(0)
  ds_write_b32 v123, v122 offset:16
  s_endpgm
k1_kgen:
  s_lshr_b32 s23, s3, 1
  s_and_b32 s24, s3, 1
  s_lshl_b32 s25, s20, 1
  s_add_u32 s25, s25, s23
  s_lshl_b32 s26, s25, 8
  s_lshl_b32 s27, s24, 7
  s_add_u32 s26, s26, s27
  v_lshlrev_b32 v1, 1, v0
  v_add_u32 v1, s26, v1
  s_lshl_b32 s27, s20, 2
  s_mov_b32 s58, 0x10000000
  s_mov_b32 s59, 0x00020000
  s_cmp_lt_u32 s2, 2
  s_cselect_b32 s33, 3, 0xff
  s_cmp_eq_u32 s33, s3
  s_cselect_b32 s33, 1, 0
  s_waitcnt lgkmcnt(0)
  s_mov_b32 s56, s54
  s_mov_b32 s57, s55
  s_lshl_b32 s35, s3, 2
  s_add_u32 s22, s22, s35
  s_lshl_b32 s22, s22, 10
  v_lshlrev_b32 v38, 4, v0
  v_add_u32 v38, s22, v38
  global_load_dwordx4 v[40:43], v38, s[4:5]
  s_mul_i32 s22, s3, 2112
  s_add_u32 s22, s22, 125312
  v_lshlrev_b32 v39, 5, v0
  v_add_u32 v39, s22, v39
  s_cmp_eq_u32 s33, 1
  s_cbranch_scc0 k1_noz
  v_mov_b32 v8, 0
  v_and_b32 v2, 31, v0
  v_mul_u32_u24 v2, 64, v2
  v_lshrrev_b32 v3, 5, v0
  v_mul_u32_u24 v3, 0, v3
  v_add_u32 v2, v2, v3
  s_mul_i32 s34, s2, 8192
  s_add_u32 s34, s34, 25690112
  v_mul_u32_u24 v2, 64, v0
  buffer_store_dword v8, v2, s[56:59], s34 offen sc1
  s_add_u32 s34, s34, 4096
  buffer_store_dword v8, v2, s[56:59], s34 offen sc1
  s_add_u32 s34, s34, 4096
k1_noz:
  global_load_ushort v4, v1, s[6:7]
  global_load_ushort v5, v1, s[8:9]
  global_load_ushort v6, v1, s[10:11]
  global_load_ushort v7, v1, s[12:13]
  s_load_dword s28, s[14:15], s27
  s_load_dword s29, s[16:17], s27
  s_mul_i32 s34, s23, 4160
  s_add_u32 s34, s34, 88064
  v_mov_b32 v8, 0
  v_mov_b32 v9, 0
  v_lshlrev_b32 v10, 3, v0
  s_lshl_b32 s35, s3, 9
  s_add_u32 s35, s35, 69632
  v_add_u32 v10, s35, v10
  ds_write_b64 v10, v[8:9]
  v_and_b32 v10, 7, v0
  v_lshlrev_b32 v10, 3, v10
  v_add_u32 v10, s34, v10
  ds_write_b64 v10, v[8:9]
  s_mul_i32 s35, s23, 2080
  s_add_u32 s35, s35, 96384
  v_and_b32 v10, 1, v0
  v_lshlrev_b32 v10, 3, v10
  v_add_u32 v10, s35, v10
  ds_write_b64 v10, v[8:9]
  v_lshrrev_b32 v8, 5, v0
  v_bfe_u32 v9, v0, 2, 2
  v_bfe_u32 v10, v0, 4, 1
  v_and_b32 v11, 3, v0
  v_lshl_add_u32 v10, v10, 2, v11
  v_sub_u32 v12, v10, v8
  v_lshlrev_b32 v13, 8, v12
  v_lshl_add_u32 v13, v9, 6, v13
  v_add_u32 v13, 70144, v13
  v_and_b32 v14, 3, v12
  v_xor_b32 v14, s23, v14
  v_lshl_add_u32 v112, v14, 4, v13
  v_xor_b32 v14, 2, v14
  v_lshl_add_u32 v113, v14, 4, v13
  v_and_b32 v12, 1, v0
  v_lshlrev_b32 v12, 5, v12
  v_bfe_u32 v13, v0, 4, 1
  v_lshl_add_u32 v12, v13, 4, v12
  v_bfe_u32 v13, v0, 1, 1
  v_lshl_add_u32 v12, v13, 3, v12
  v_lshl_add_u32 v12, v8, 6, v12
  v_lshlrev_b32 v13, 3, v9
  v_sub_u32 v12, v12, v13
  s_add_u32 s36, s34, 32
  v_add_u32 v114, s36, v12
  v_lshl_add_u32 v12, v10, 1, v8
  v_lshlrev_b32 v12, 4, v12
  v_lshl_add_u32 v12, v9, 2, v12
  v_add_u32 v115, s35, v12
  s_add_u32 s35, s23, 2
  v_xor_b32 v12, s35, v11
  v_lshlrev_b32 v12, 4, v12
  v_lshl_add_u32 v12, v10, 8, v12
  v_lshl_add_u32 v12, v9, 6, v12
  v_lshl_add_u32 v12, v8, 3, v12
  v_add_u32 v116, 71680, v12
  s_and_b32 s35, s25, 3
  v_xor_b32 v12, s35, v11
  v_lshlrev_b32 v12, 6, v12
  s_bfe_u32 s35, s25, 0x10003
  s_lshl_b32 s35, s35, 1
  v_xor_b32 v13, s35, v9
  v_lshl_add_u32 v12, v13, 4, v12
  v_lshl_add_u32 v12, v8, 3, v12
  v_bfe_u32 v13, v0, 4, 1
  v_lshl_add_u32 v12, v13, 17, v12
  s_lshl_b32 s35, s25, 8
  v_add_u32 v117, s35, v12
  s_mul_i32 s30, s3, 17408
  s_mov_b32 m0, s30
  s_mov_b32 s40, 0x3fb8aa3b
  s_mov_b32 s41, 0x32a57060
  s_mov_b32 s42, 0x3f317218
  v_and_b32 v2, 31, v0
  v_mul_u32_u24 v2, 272, v2
  v_lshrrev_b32 v3, 5, v0
  v_lshlrev_b32 v3, 4, v3
  v_add3_u32 v2, v2, v3, s30
  v_mov_b32 v8, 0x3f80
  ds_write_addtid_b32 v8 offset:8704
  s_lshl_b32 s31, s23, 4
  s_waitcnt lgkmcnt(0)
  s_lshr_b32 s28, s28, s31
  s_lshl_b32 s28, s28, 16
  s_lshr_b32 s29, s29, s31
  s_lshl_b32 s29, s29, 16
  v_mov_b32 v9, s28
  v_mul_f32 v11, s40, v9
  v_fma_f32 v12, v9, s40, -v11
  v_exp_f32 v10, v11
  v_fmac_f32 v12, s41, v9
  v_mul_f32 v12, s42, v12
  v_fmac_f32 v10, v10, v12
  v_cvt_pk_bf16_f32 v10, v10, v10
  v_lshlrev_b32 v10, 16, v10
  v_add_f32 v11, v10, v10
  s_cmp_eq_u32 s3, 3
  s_cbranch_scc1 k1_nda
  s_cmp_ge_u32 s2, 224
  s_cbranch_scc1 k1_nda
  s_and_b32 s35, s2, 7
  s_lshr_b32 s36, s2, 3
  s_cmp_eq_u32 s3, 2
  s_cselect_b32 s38, s36, s35
  s_cselect_b32 s39, s35, s36
  s_movk_i32 s35, 3584
  s_cselect_b32 s35, 1024, s35
  s_cselect_b32 s16, s48, s44
  s_cselect_b32 s17, s49, s45
  s_cmp_eq_u32 s3, 1
  s_cselect_b32 s16, s46, s16
  s_cselect_b32 s17, s47, s17
  s_mov_b32 s18, 1835008
  s_mov_b32 s19, 0x00020000
  s_mul_i32 s38, s38, s35
  s_lshl_b32 s38, s38, 6
  s_lshl_b32 s39, s39, 7
  s_add_u32 s38, s38, s39
  s_lshl_b32 s39, s35, 3
  v_lshrrev_b32 v12, 3, v0
  v_mul_u32_u24 v12, s35, v12
  v_and_b32 v13, 7, v0
  v_lshl_add_u32 v12, v13, 4, v12
  s_mul_i32 s35, s3, 8256
  s_add_u32 m0, s35, 100608
  s_nop 0
  buffer_load_dwordx4 v12, s[16:19], s38 offen lds
  s_add_u32 m0, m0, 1024
  s_add_u32 s38, s38, s39
  buffer_load_dwordx4 v12, s[16:19], s38 offen lds
  s_add_u32 m0, m0, 1024
  s_add_u32 s38, s38, s39
  buffer_load_dwordx4 v12, s[16:19], s38 offen lds
  s_add_u32 m0, m0, 1024
  s_add_u32 s38, s38, s39
  buffer_load_dwordx4 v12, s[16:19], s38 offen lds
  s_add_u32 m0, m0, 1024
  s_add_u32 s38, s38, s39
  buffer_load_dwordx4 v12, s[16:19], s38 offen lds
  s_add_u32 m0, m0, 1024
  s_add_u32 s38, s38, s39
  buffer_load_dwordx4 v12, s[16:19], s38 offen lds
  s_add_u32 m0, m0, 1024
  s_add_u32 s38, s38, s39
  buffer_load_dwordx4 v12, s[16:19], s38 offen lds
  s_add_u32 m0, m0, 1024
  s_add_u32 s38, s38, s39
  buffer_load_dwordx4 v12, s[16:19], s38 offen lds
  s_mov_b32 m0, s30
  s_mov_b32 s33, 8
k1_nda:
  s_cmp_lg_u32 s33, 1
  s_cbranch_scc1 k1_nz2
  s_waitcnt vmcnt(6)
  s_branch k1_nz3
k1_nz2:
  s_cmp_eq_u32 s33, 8
  s_cbranch_scc1 k1_wax
  s_waitcnt vmcnt(4)
k1_wax:
  s_waitcnt vmcnt(12)
k1_nz3:
  v_lshlrev_b32 v44, 16, v40
  v_and_b32 v45, s60, v40
  v_lshlrev_b32 v46, 16, v41
  v_and_b32 v47, s60, v41
  v_lshlrev_b32 v48, 16, v42
  v_and_b32 v49, s60, v42
  v_lshlrev_b32 v50, 16, v43
  v_and_b32 v51, s60, v43
  v_pk_add_f32 v[52:53], v[44:45], v[46:47]
  v_pk_add_f32 v[54:55], v[48:49], v[50:51]
  v_pk_add_f32 v[52:53], v[52:53], v[54:55]
  v_add_f32 v52, v52, v53
  s_nop 1
  v_add_f32_dpp v52, v52, v52 row_ror:8 row_mask:0xf bank_mask:0xf
  s_nop 1
  v_add_f32_dpp v52, v52, v52 row_ror:4 row_mask:0xf bank_mask:0xf
  s_nop 1
  v_add_f32_dpp v52, v52, v52 row_ror:2 row_mask:0xf bank_mask:0xf
  s_nop 1
  v_add_f32_dpp v52, v52, v52 row_ror:1 row_mask:0xf bank_mask:0xf
  s_nop 1
  v_add_f32_dpp v52, v52, v52 row_bcast:15 row_mask:0xa bank_mask:0xf
  s_nop 1
  v_add_f32_dpp v52, v52, v52 row_bcast:31 row_mask:0xc bank_mask:0xf
  s_nop 0
  v_readlane_b32 s26, v52, 63
  s_nop 1
  v_mov_b32 v56, s26
  v_mul_f32 v56, s61, v56
  v_pk_add_f32 v[58:59], v[44:45], v[56:57] op_sel_hi:[1,0] neg_lo:[0,1] neg_hi:[0,1]
  v_pk_add_f32 v[60:61], v[46:47], v[56:57] op_sel_hi:[1,0] neg_lo:[0,1] neg_hi:[0,1]
  v_pk_add_f32 v[62:63], v[48:49], v[56:57] op_sel_hi:[1,0] neg_lo:[0,1] neg_hi:[0,1]
  v_pk_add_f32 v[64:65], v[50:51], v[56:57] op_sel_hi:[1,0] neg_lo:[0,1] neg_hi:[0,1]
  v_pk_mul_f32 v[52:53], v[58:59], v[58:59]
  v_pk_fma_f32 v[52:53], v[60:61], v[60:61], v[52:53]
  v_pk_fma_f32 v[52:53], v[62:63], v[62:63], v[52:53]
  v_pk_fma_f32 v[52:53], v[64:65], v[64:65], v[52:53]
  v_cvt_pk_bf16_f32 v56, v56, v56
  v_add_f32 v52, v52, v53
  v_lshlrev_b32 v56, 16, v56
  s_nop 0
  v_add_f32_dpp v52, v52, v52 row_ror:8 row_mask:0xf bank_mask:0xf
  s_nop 1
  v_add_f32_dpp v52, v52, v52 row_ror:4 row_mask:0xf bank_mask:0xf
  s_nop 1
  v_add_f32_dpp v52, v52, v52 row_ror:2 row_mask:0xf bank_mask:0xf
  s_nop 1
  v_add_f32_dpp v52, v52, v52 row_ror:1 row_mask:0xf bank_mask:0xf
  s_nop 1
  v_add_f32_dpp v52, v52, v52 row_bcast:15 row_mask:0xa bank_mask:0xf
  s_nop 1
  v_add_f32_dpp v52, v52, v52 row_bcast:31 row_mask:0xc bank_mask:0xf
  s_nop 0
  v_readlane_b32 s27, v52, 63
  v_pk_add_f32 v[58:59], v[44:45], v[56:57] op_sel_hi:[1,0] neg_lo:[0,1] neg_hi:[0,1]
  v_pk_add_f32 v[60:61], v[46:47], v[56:57] op_sel_hi:[1,0] neg_lo:[0,1] neg_hi:[0,1]
  v_pk_add_f32 v[62:63], v[48:49], v[56:57] op_sel_hi:[1,0] neg_lo:[0,1] neg_hi:[0,1]
  v_pk_add_f32 v[64:65], v[50:51], v[56:57] op_sel_hi:[1,0] neg_lo:[0,1] neg_hi:[0,1]
  v_mov_b32 v54, s27
  v_mul_f32 v54, s61, v54
  v_cvt_pk_bf16_f32 v54, v54, v54
  v_lshlrev_b32 v54, 16, v54
  v_add_f32 v54, 0x3727c5ac, v54
  v_cvt_pk_bf16_f32 v54, v54, v54
  v_lshlrev_b32 v54, 16, v54
  v_sqrt_f32 v54, v54
  v_cvt_pk_bf16_f32 v66, v58, v59
  v_cvt_pk_bf16_f32 v67, v60, v61
  v_cvt_pk_bf16_f32 v68, v62, v63
  v_cvt_pk_bf16_f32 v69, v64, v65
  v_cvt_pk_bf16_f32 v54, v54, v54
  v_lshlrev_b32 v54, 16, v54
  v_rcp_f32 v54, v54
  v_lshlrev_b32 v58, 16, v66
  v_and_b32 v59, s60, v66
  v_lshlrev_b32 v60, 16, v67
  v_and_b32 v61, s60, v67
  v_lshlrev_b32 v62, 16, v68
  v_and_b32 v63, s60, v68
  v_lshlrev_b32 v64, 16, v69
  v_and_b32 v65, s60, v69
  v_pk_mul_f32 v[58:59], v[58:59], v[54:55] op_sel_hi:[1,0]
  v_pk_mul_f32 v[60:61], v[60:61], v[54:55] op_sel_hi:[1,0]
  v_pk_mul_f32 v[62:63], v[62:63], v[54:55] op_sel_hi:[1,0]
  v_pk_mul_f32 v[64:65], v[64:65], v[54:55] op_sel_hi:[1,0]
  v_cvt_pk_bf16_f32 v44, v58, v59
  v_mov_b32 v45, v40
  v_cvt_pk_bf16_f32 v46, v60, v61
  v_mov_b32 v47, v41
  v_cvt_pk_bf16_f32 v48, v62, v63
  v_mov_b32 v49, v42
  v_cvt_pk_bf16_f32 v50, v64, v65
  v_mov_b32 v51, v43
  ds_write_b128 v39, v[44:47]
  ds_write_b128 v39, v[48:51] offset:16
  s_waitcnt lgkmcnt(0)
  s_barrier
  s_cmp_lg_u32 s33, 1
  s_cbranch_scc1 k1_nopub
  v_mov_b32 v12, s2
  v_lshlrev_b32 v12, 7, v12
  v_mov_b32 v13, 1
  s_mov_b64 exec, 1
  s_waitcnt vmcnt(4)
  global_store_dword v12, v13, s[52:53] sc1
  s_mov_b64 exec, -1
  s_waitcnt vmcnt(1)
  s_branch k1_pub
k1_nopub:
  s_cmp_eq_u32 s33, 8
  s_cbranch_scc1 k1_wap
  s_waitcnt vmcnt(0)
k1_wap:
  s_waitcnt vmcnt(8)
k1_pub:
  v_lshlrev_b32 v4, 16, v4
  v_lshlrev_b32 v5, 16, v5
  v_lshlrev_b32 v6, 16, v6
  v_lshlrev_b32 v7, 16, v7
  v_mul_f32 v13, s40, v4
  v_fma_f32 v14, v4, s40, -v13
  v_exp_f32 v12, v13
  v_fmac_f32 v14, s41, v4
  v_mul_f32 v14, s42, v14
  v_fmac_f32 v12, v12, v14
  v_mul_f32 v5, v5, v10
  v_mul_f32 v20, v6, v11
  v_mul_f32 v21, v7, v11
  v_cvt_pk_bf16_f32 v12, v12, v12
  v_lshlrev_b32 v12, 16, v12
  v_mul_f32 v12, v12, v10
  v_mul_f32 v12, -v12, s40
  v_mul_f32 v5, 0.15915494, v5
  v_fract_f32 v6, v5
  v_exp_f32 v7, v12
  v_cos_f32 v14, v6
  v_sin_f32 v15, v6
  v_mul_f32 v8, 0x41000000, v5
  v_mul_f32 v9, 0x41000000, v12
  v_fract_f32 v8, v8
  v_exp_f32 v9, v9
  v_cos_f32 v16, v8
  v_sin_f32 v17, v8
  v_mul_f32 v10, 0x43800000, v5
  v_mul_f32 v11, 0x43800000, v12
  v_fract_f32 v10, v10
  v_exp_f32 v11, v11
  v_cos_f32 v18, v10
  v_sin_f32 v19, v10
  v_pk_mul_f32 v[14:15], v[14:15], v[6:7] op_sel:[0,1] op_sel_hi:[1,1]
  v_pk_mul_f32 v[16:17], v[16:17], v[8:9] op_sel:[0,1] op_sel_hi:[1,1]
  v_pk_mul_f32 v[18:19], v[18:19], v[10:11] op_sel:[0,1] op_sel_hi:[1,1]
  v_cvt_pk_bf16_f32 v12, v20, -v21
  ds_write_addtid_b32 v12 offset:0
  v_cvt_pk_bf16_f32 v13, v16, v17
  ds_write_addtid_b32 v13 offset:8976
  v_pk_mul_f32 v[6:7], v[14:15], v[14:15] op_sel:[1,1] op_sel_hi:[1,0]
  v_pk_fma_f32 v[22:23], v[14:15], v[14:15], v[6:7] op_sel_hi:[0,1,1] neg_lo:[0,0,1]
  v_pk_mul_f32 v[8:9], v[20:21], v[14:15] op_sel:[1,1] op_sel_hi:[1,0]
  v_pk_fma_f32 v[26:27], v[20:21], v[14:15], v[8:9] op_sel_hi:[0,1,1] neg_lo:[0,0,1]
  v_cvt_pk_bf16_f32 v3, v26, -v27
  ds_write_addtid_b32 v3 offset:272
  v_pk_mul_f32 v[10:11], v[22:23], v[22:23] op_sel:[1,1] op_sel_hi:[1,0]
  v_pk_fma_f32 v[24:25], v[22:23], v[22:23], v[10:11] op_sel_hi:[0,1,1] neg_lo:[0,0,1]
  v_pk_mul_f32 v[4:5], v[20:21], v[22:23] op_sel:[1,1] op_sel_hi:[1,0]
  v_pk_fma_f32 v[28:29], v[20:21], v[22:23], v[4:5] op_sel_hi:[0,1,1] neg_lo:[0,0,1]
  v_cvt_pk_bf16_f32 v12, v28, -v29
  ds_write_addtid_b32 v12 offset:544
  v_pk_mul_f32 v[6:7], v[26:27], v[22:23] op_sel:[1,1] op_sel_hi:[1,0]
  v_pk_fma_f32 v[30:31], v[26:27], v[22:23], v[6:7] op_sel_hi:[0,1,1] neg_lo:[0,0,1]
  v_cvt_pk_bf16_f32 v13, v30, -v31
  ds_write_addtid_b32 v13 offset:816
  v_pk_mul_f32 v[8:9], v[20:21], v[24:25] op_sel:[1,1] op_sel_hi:[1,0]
  v_pk_fma_f32 v[32:33], v[20:21], v[24:25], v[8:9] op_sel_hi:[0,1,1] neg_lo:[0,0,1]
  v_cvt_pk_bf16_f32 v3, v32, -v33
  ds_write_addtid_b32 v3 offset:1088
  v_pk_mul_f32 v[10:11], v[26:27], v[24:25] op_sel:[1,1] op_sel_hi:[1,0]
  v_pk_fma_f32 v[34:35], v[26:27], v[24:25], v[10:11] op_sel_hi:[0,1,1] neg_lo:[0,0,1]
  v_cvt_pk_bf16_f32 v12, v34, -v35
  ds_write_addtid_b32 v12 offset:1360
  v_pk_mul_f32 v[4:5], v[28:29], v[24:25] op_sel:[1,1] op_sel_hi:[1,0]
  v_pk_fma_f32 v[36:37], v[28:29], v[24:25], v[4:5] op_sel_hi:[0,1,1] neg_lo:[0,0,1]
  v_cvt_pk_bf16_f32 v13, v36, -v37
  ds_write_addtid_b32 v13 offset:1632
  v_pk_mul_f32 v[6:7], v[30:31], v[24:25] op_sel:[1,1] op_sel_hi:[1,0]
  v_pk_fma_f32 v[38:39], v[30:31], v[24:25], v[6:7] op_sel_hi:[0,1,1] neg_lo:[0,0,1]
  v_cvt_pk_bf16_f32 v3, v38, -v39
  ds_write_addtid_b32 v3 offset:1904
  v_pk_mul_f32 v[8:9], v[20:21], v[18:19] op_sel:[1,1] op_sel_hi:[1,0]
  v_pk_fma_f32 v[40:41], v[20:21], v[18:19], v[8:9] op_sel_hi:[0,1,1] neg_lo:[0,0,1]
  v_cvt_pk_bf16_f32 v12, v40, -v41
  ds_write_addtid_b32 v12 offset:2176
  v_pk_mul_f32 v[10:11], v[28:29], v[18:19] op_sel:[1,1] op_sel_hi:[1,0]
  v_pk_fma_f32 v[42:43], v[28:29], v[18:19], v[10:11] op_sel_hi:[0,1,1] neg_lo:[0,0,1]
  v_cvt_pk_bf16_f32 v13, v42, -v43
  ds_write_addtid_b32 v13 offset:2448
  v_pk_mul_f32 v[4:5], v[32:33], v[18:19] op_sel:[1,1] op_sel_hi:[1,0]
  v_pk_fma_f32 v[44:45], v[32:33], v[18:19], v[4:5] op_sel_hi:[0,1,1] neg_lo:[0,0,1]
  v_cvt_pk_bf16_f32 v3, v44, -v45
  ds_write_addtid_b32 v3 offset:2720
  ds_write_addtid_b32 v3 offset:3264
  v_pk_mul_f32 v[6:7], v[36:37], v[18:19] op_sel:[1,1] op_sel_hi:[1,0]
  v_pk_fma_f32 v[46:47], v[36:37], v[18:19], v[6:7] op_sel_hi:[0,1,1] neg_lo:[0,0,1]
  v_cvt_pk_bf16_f32 v12, v46, -v47
  ds_write_addtid_b32 v12 offset:3536
  v_pk_mul_f32 v[8:9], v[40:41], v[16:17] op_sel:[1,1] op_sel_hi:[1,0]
  v_pk_fma_f32 v[48:49], v[40:41], v[16:17], v[8:9] op_sel_hi:[0,1,1] neg_lo:[0,0,1]
  v_cvt_pk_bf16_f32 v13, v48, -v49
  ds_write_addtid_b32 v13 offset:3808
  v_pk_mul_f32 v[10:11], v[40:41], v[18:19] op_sel:[1,1] op_sel_hi:[1,0]
  v_pk_fma_f32 v[50:51], v[40:41], v[18:19], v[10:11] op_sel_hi:[0,1,1] neg_lo:[0,0,1]
  v_cvt_pk_bf16_f32 v3, v50, -v51
  ds_write_addtid_b32 v3 offset:4352
  v_pk_mul_f32 v[4:5], v[44:45], v[18:19] op_sel:[1,1] op_sel_hi:[1,0]
  v_pk_fma_f32 v[52:53], v[44:45], v[18:19], v[4:5] op_sel_hi:[0,1,1] neg_lo:[0,0,1]
  v_cvt_pk_bf16_f32 v12, v52, -v53
  ds_write_addtid_b32 v12 offset:4624
  v_pk_mul_f32 v[6:7], v[48:49], v[18:19] op_sel:[1,1] op_sel_hi:[1,0]
  v_pk_fma_f32 v[54:55], v[48:49], v[18:19], v[6:7] op_sel_hi:[0,1,1] neg_lo:[0,0,1]
  v_cvt_pk_bf16_f32 v13, v54, -v55
  ds_write_addtid_b32 v13 offset:4896
  v_pk_mul_f32 v[8:9], v[50:51], v[18:19] op_sel:[1,1] op_sel_hi:[1,0]
  v_pk_fma_f32 v[56:57], v[50:51], v[18:19], v[8:9] op_sel_hi:[0,1,1] neg_lo:[0,0,1]
  v_cvt_pk_bf16_f32 v3, v56, -v57
  ds_write_addtid_b32 v3 offset:5440
  v_pk_mul_f32 v[10:11], v[52:53], v[18:19] op_sel:[1,1] op_sel_hi:[1,0]
  v_pk_fma_f32 v[58:59], v[52:53], v[18:19], v[10:11] op_sel_hi:[0,1,1] neg_lo:[0,0,1]
  v_cvt_pk_bf16_f32 v12, v58, -v59
  ds_write_addtid_b32 v12 offset:5712
  v_pk_mul_f32 v[4:5], v[54:55], v[18:19] op_sel:[1,1] op_sel_hi:[1,0]
  v_pk_fma_f32 v[60:61], v[54:55], v[18:19], v[4:5] op_sel_hi:[0,1,1] neg_lo:[0,0,1]
  v_cvt_pk_bf16_f32 v13, v60, -v61
  ds_write_addtid_b32 v13 offset:5984
  v_pk_mul_f32 v[6:7], v[56:57], v[18:19] op_sel:[1,1] op_sel_hi:[1,0]
  v_pk_fma_f32 v[62:63], v[56:57], v[18:19], v[6:7] op_sel_hi:[0,1,1] neg_lo:[0,0,1]
  v_cvt_pk_bf16_f32 v3, v62, -v63
  ds_write_addtid_b32 v3 offset:6528
  v_pk_mul_f32 v[8:9], v[60:61], v[18:19] op_sel:[1,1] op_sel_hi:[1,0]
  v_pk_fma_f32 v[64:65], v[60:61], v[18:19], v[8:9] op_sel_hi:[0,1,1] neg_lo:[0,0,1]
  v_cvt_pk_bf16_f32 v12, v64, -v65
  ds_write_addtid_b32 v12 offset:6800
  v_pk_mul_f32 v[10:11], v[62:63], v[18:19] op_sel:[1,1] op_sel_hi:[1,0]
  v_pk_fma_f32 v[66:67], v[62:63], v[18:19], v[10:11] op_sel_hi:[0,1,1] neg_lo:[0,0,1]
  v_cvt_pk_bf16_f32 v13, v66, -v67
  ds_write_addtid_b32 v13 offset:7072
  v_pk_mul_f32 v[4:5], v[64:65], v[18:19] op_sel:[1,1] op_sel_hi:[1,0]
  v_pk_fma_f32 v[68:69], v[64:65], v[18:19], v[4:5] op_sel_hi:[0,1,1] neg_lo:[0,0,1]
  v_cvt_pk_bf16_f32 v3, v68, -v69
  ds_write_addtid_b32 v3 offset:7344
  v_pk_mul_f32 v[6:7], v[66:67], v[18:19] op_sel:[1,1] op_sel_hi:[1,0]
  v_pk_fma_f32 v[70:71], v[66:67], v[18:19], v[6:7] op_sel_hi:[0,1,1] neg_lo:[0,0,1]
  v_cvt_pk_bf16_f32 v12, v70, -v71
  ds_write_addtid_b32 v12 offset:7616
  v_pk_mul_f32 v[8:9], v[68:69], v[18:19] op_sel:[1,1] op_sel_hi:[1,0]
  v_pk_fma_f32 v[72:73], v[68:69], v[18:19], v[8:9] op_sel_hi:[0,1,1] neg_lo:[0,0,1]
  v_cvt_pk_bf16_f32 v13, v72, -v73
  ds_write_addtid_b32 v13 offset:7888
  v_pk_mul_f32 v[10:11], v[70:71], v[18:19] op_sel:[1,1] op_sel_hi:[1,0]
  v_pk_fma_f32 v[74:75], v[70:71], v[18:19], v[10:11] op_sel_hi:[0,1,1] neg_lo:[0,0,1]
  v_cvt_pk_bf16_f32 v3, v74, -v75
  ds_write_addtid_b32 v3 offset:8160
  v_pk_mul_f32 v[4:5], v[72:73], v[18:19] op_sel:[1,1] op_sel_hi:[1,0]
  v_pk_fma_f32 v[76:77], v[72:73], v[18:19], v[4:5] op_sel_hi:[0,1,1] neg_lo:[0,0,1]
  v_cvt_pk_bf16_f32 v12, v76, -v77
  ds_write_addtid_b32 v12 offset:8432
  v_pk_mul_f32 v[6:7], v[16:17], v[16:17] op_sel:[1,1] op_sel_hi:[1,0]
  v_pk_fma_f32 v[20:21], v[16:17], v[16:17], v[6:7] op_sel_hi:[0,1,1] neg_lo:[0,0,1]
  v_cvt_pk_bf16_f32 v13, v20, v21
  ds_write_addtid_b32 v13 offset:9248
  v_pk_mul_f32 v[8:9], v[20:21], v[16:17] op_sel:[1,1] op_sel_hi:[1,0]
  v_pk_fma_f32 v[22:23], v[20:21], v[16:17], v[8:9] op_sel_hi:[0,1,1] neg_lo:[0,0,1]
  v_cvt_pk_bf16_f32 v3, v22, v23
  ds_write_addtid_b32 v3 offset:9520
  v_pk_mul_f32 v[10:11], v[20:21], v[20:21] op_sel:[1,1] op_sel_hi:[1,0]
  v_pk_fma_f32 v[24:25], v[20:21], v[20:21], v[10:11] op_sel_hi:[0,1,1] neg_lo:[0,0,1]
  v_cvt_pk_bf16_f32 v12, v24, v25
  ds_write_addtid_b32 v12 offset:9792
  v_pk_mul_f32 v[4:5], v[16:17], v[24:25] op_sel:[1,1] op_sel_hi:[1,0]
  v_pk_fma_f32 v[26:27], v[16:17], v[24:25], v[4:5] op_sel_hi:[0,1,1] neg_lo:[0,0,1]
  v_cvt_pk_bf16_f32 v13, v26, v27
  ds_write_addtid_b32 v13 offset:10064
  v_pk_mul_f32 v[6:7], v[20:21], v[24:25] op_sel:[1,1] op_sel_hi:[1,0]
  v_pk_fma_f32 v[28:29], v[20:21], v[24:25], v[6:7] op_sel_hi:[0,1,1] neg_lo:[0,0,1]
  v_cvt_pk_bf16_f32 v3, v28, v29
  ds_write_addtid_b32 v3 offset:10336
  v_pk_mul_f32 v[8:9], v[22:23], v[24:25] op_sel:[1,1] op_sel_hi:[1,0]
  v_pk_fma_f32 v[30:31], v[22:23], v[24:25], v[8:9] op_sel_hi:[0,1,1] neg_lo:[0,0,1]
  v_cvt_pk_bf16_f32 v12, v30, v31
  ds_write_addtid_b32 v12 offset:10608
  v_pk_mul_f32 v[10:11], v[24:25], v[24:25] op_sel:[1,1] op_sel_hi:[1,0]
  v_pk_fma_f32 v[32:33], v[24:25], v[24:25], v[10:11] op_sel_hi:[0,1,1] neg_lo:[0,0,1]
  v_cvt_pk_bf16_f32 v13, v32, v33
  ds_write_addtid_b32 v13 offset:10880
  v_pk_mul_f32 v[4:5], v[16:17], v[32:33] op_sel:[1,1] op_sel_hi:[1,0]
  v_pk_fma_f32 v[34:35], v[16:17], v[32:33], v[4:5] op_sel_hi:[0,1,1] neg_lo:[0,0,1]
  v_cvt_pk_bf16_f32 v3, v34, v35
  ds_write_addtid_b32 v3 offset:11152
  v_pk_mul_f32 v[6:7], v[20:21], v[32:33] op_sel:[1,1] op_sel_hi:[1,0]
  v_pk_fma_f32 v[36:37], v[20:21], v[32:33], v[6:7] op_sel_hi:[0,1,1] neg_lo:[0,0,1]
  v_cvt_pk_bf16_f32 v12, v36, v37
  ds_write_addtid_b32 v12 offset:11424
  v_pk_mul_f32 v[8:9], v[22:23], v[32:33] op_sel:[1,1] op_sel_hi:[1,0]
  v_pk_fma_f32 v[38:39], v[22:23], v[32:33], v[8:9] op_sel_hi:[0,1,1] neg_lo:[0,0,1]
  v_cvt_pk_bf16_f32 v13, v38, v39
  ds_write_addtid_b32 v13 offset:11696
  v_pk_mul_f32 v[10:11], v[24:25], v[32:33] op_sel:[1,1] op_sel_hi:[1,0]
  v_pk_fma_f32 v[40:41], v[24:25], v[32:33], v[10:11] op_sel_hi:[0,1,1] neg_lo:[0,0,1]
  v_cvt_pk_bf16_f32 v3, v40, v41
  ds_write_addtid_b32 v3 offset:11968
  v_pk_mul_f32 v[4:5], v[26:27], v[32:33] op_sel:[1,1] op_sel_hi:[1,0]
  v_pk_fma_f32 v[42:43], v[26:27], v[32:33], v[4:5] op_sel_hi:[0,1,1] neg_lo:[0,0,1]
  v_cvt_pk_bf16_f32 v12, v42, v43
  ds_write_addtid_b32 v12 offset:12240
  v_pk_mul_f32 v[6:7], v[28:29], v[32:33] op_sel:[1,1] op_sel_hi:[1,0]
  v_pk_fma_f32 v[44:45], v[28:29], v[32:33], v[6:7] op_sel_hi:[0,1,1] neg_lo:[0,0,1]
  v_cvt_pk_bf16_f32 v13, v44, v45
  ds_write_addtid_b32 v13 offset:12512
  v_pk_mul_f32 v[8:9], v[30:31], v[32:33] op_sel:[1,1] op_sel_hi:[1,0]
  v_pk_fma_f32 v[46:47], v[30:31], v[32:33], v[8:9] op_sel_hi:[0,1,1] neg_lo:[0,0,1]
  v_cvt_pk_bf16_f32 v3, v46, v47
  ds_write_addtid_b32 v3 offset:12784
  v_pk_mul_f32 v[10:11], v[32:33], v[32:33] op_sel:[1,1] op_sel_hi:[1,0]
  v_pk_fma_f32 v[48:49], v[32:33], v[32:33], v[10:11] op_sel_hi:[0,1,1] neg_lo:[0,0,1]
  v_cvt_pk_bf16_f32 v12, v48, v49
  ds_write_addtid_b32 v12 offset:13056
  v_pk_mul_f32 v[4:5], v[16:17], v[48:49] op_sel:[1,1] op_sel_hi:[1,0]
  v_pk_fma_f32 v[50:51], v[16:17], v[48:49], v[4:5] op_sel_hi:[0,1,1] neg_lo:[0,0,1]
  v_cvt_pk_bf16_f32 v13, v50, v51
  ds_write_addtid_b32 v13 offset:13328
  v_pk_mul_f32 v[6:7], v[20:21], v[48:49] op_sel:[1,1] op_sel_hi:[1,0]
  v_pk_fma_f32 v[52:53], v[20:21], v[48:49], v[6:7] op_sel_hi:[0,1,1] neg_lo:[0,0,1]
  v_cvt_pk_bf16_f32 v3, v52, v53
  ds_write_addtid_b32 v3 offset:13600
  v_pk_mul_f32 v[8:9], v[22:23], v[48:49] op_sel:[1,1] op_sel_hi:[1,0]
  v_pk_fma_f32 v[54:55], v[22:23], v[48:49], v[8:9] op_sel_hi:[0,1,1] neg_lo:[0,0,1]
  v_cvt_pk_bf16_f32 v12, v54, v55
  ds_write_addtid_b32 v12 offset:13872
  v_pk_mul_f32 v[10:11], v[24:25], v[48:49] op_sel:[1,1] op_sel_hi:[1,0]
  v_pk_fma_f32 v[56:57], v[24:25], v[48:49], v[10:11] op_sel_hi:[0,1,1] neg_lo:[0,0,1]
  v_cvt_pk_bf16_f32 v13, v56, v57
  ds_write_addtid_b32 v13 offset:14144
  v_pk_mul_f32 v[4:5], v[26:27], v[48:49] op_sel:[1,1] op_sel_hi:[1,0]
  v_pk_fma_f32 v[58:59], v[26:27], v[48:49], v[4:5] op_sel_hi:[0,1,1] neg_lo:[0,0,1]
  v_cvt_pk_bf16_f32 v3, v58, v59
  ds_write_addtid_b32 v3 offset:14416
  v_pk_mul_f32 v[6:7], v[28:29], v[48:49] op_sel:[1,1] op_sel_hi:[1,0]
  v_pk_fma_f32 v[60:61], v[28:29], v[48:49], v[6:7] op_sel_hi:[0,1,1] neg_lo:[0,0,1]
  v_cvt_pk_bf16_f32 v12, v60, v61
  ds_write_addtid_b32 v12 offset:14688
  v_pk_mul_f32 v[8:9], v[30:31], v[48:49] op_sel:[1,1] op_sel_hi:[1,0]
  v_pk_fma_f32 v[62:63], v[30:31], v[48:49], v[8:9] op_sel_hi:[0,1,1] neg_lo:[0,0,1]
  v_cvt_pk_bf16_f32 v13, v62, v63
  ds_write_addtid_b32 v13 offset:14960
  v_pk_mul_f32 v[10:11], v[32:33], v[48:49] op_sel:[1,1] op_sel_hi:[1,0]
  v_pk_fma_f32 v[64:65], v[32:33], v[48:49], v[10:11] op_sel_hi:[0,1,1] neg_lo:[0,0,1]
  v_cvt_pk_bf16_f32 v3, v64, v65
  ds_write_addtid_b32 v3 offset:15232
  v_pk_mul_f32 v[4:5], v[34:35], v[48:49] op_sel:[1,1] op_sel_hi:[1,0]
  v_pk_fma_f32 v[66:67], v[34:35], v[48:49], v[4:5] op_sel_hi:[0,1,1] neg_lo:[0,0,1]
  v_cvt_pk_bf16_f32 v12, v66, v67
  ds_write_addtid_b32 v12 offset:15504
  v_pk_mul_f32 v[6:7], v[36:37], v[48:49] op_sel:[1,1] op_sel_hi:[1,0]
  v_pk_fma_f32 v[68:69], v[36:37], v[48:49], v[6:7] op_sel_hi:[0,1,1] neg_lo:[0,0,1]
  v_cvt_pk_bf16_f32 v13, v68, v69
  ds_write_addtid_b32 v13 offset:15776
  v_pk_mul_f32 v[8:9], v[38:39], v[48:49] op_sel:[1,1] op_sel_hi:[1,0]
  v_pk_fma_f32 v[70:71], v[38:39], v[48:49], v[8:9] op_sel_hi:[0,1,1] neg_lo:[0,0,1]
  v_cvt_pk_bf16_f32 v3, v70, v71
  ds_write_addtid_b32 v3 offset:16048
  v_pk_mul_f32 v[10:11], v[40:41], v[48:49] op_sel:[1,1] op_sel_hi:[1,0]
  v_pk_fma_f32 v[72:73], v[40:41], v[48:49], v[10:11] op_sel_hi:[0,1,1] neg_lo:[0,0,1]
  v_cvt_pk_bf16_f32 v12, v72, v73
  ds_write_addtid_b32 v12 offset:16320
  v_pk_mul_f32 v[4:5], v[42:43], v[48:49] op_sel:[1,1] op_sel_hi:[1,0]
  v_pk_fma_f32 v[74:75], v[42:43], v[48:49], v[4:5] op_sel_hi:[0,1,1] neg_lo:[0,0,1]
  v_cvt_pk_bf16_f32 v13, v74, v75
  ds_write_addtid_b32 v13 offset:16592
  v_pk_mul_f32 v[6:7], v[44:45], v[48:49] op_sel:[1,1] op_sel_hi:[1,0]
  v_pk_fma_f32 v[76:77], v[44:45], v[48:49], v[6:7] op_sel_hi:[0,1,1] neg_lo:[0,0,1]
  v_cvt_pk_bf16_f32 v3, v76, v77
  ds_write_addtid_b32 v3 offset:16864
  v_pk_mul_f32 v[8:9], v[46:47], v[48:49] op_sel:[1,1] op_sel_hi:[1,0]
  v_pk_fma_f32 v[78:79], v[46:47], v[48:49], v[8:9] op_sel_hi:[0,1,1] neg_lo:[0,0,1]
  v_cvt_pk_bf16_f32 v12, v78, v79
  ds_write_addtid_b32 v12 offset:17136
  ds_read_b128 v[32:35], v2 offset:0
  ds_read_b128 v[36:39], v2 offset:8704
  ds_read_b128 v[40:43], v2 offset:32
  ds_read_b128 v[44:47], v2 offset:8736
  ds_read_b128 v[48:51], v2 offset:64
  ds_read_b128 v[52:55], v2 offset:8768
  ds_read_b128 v[56:59], v2 offset:96
  ds_read_b128 v[60:63], v2 offset:8800
  ds_read_b128 v[64:67], v2 offset:128
  ds_read_b128 v[68:71], v2 offset:8832
  ds_read_b128 v[72:75], v2 offset:160
  ds_read_b128 v[76:79], v2 offset:8864
  ds_read_b128 v[80:83], v2 offset:192
  ds_read_b128 v[84:87], v2 offset:8896
  ds_read_b128 v[88:91], v2 offset:224
  ds_read_b128 v[92:95], v2 offset:8928
  v_lshlrev_b32 v4, 4, v0
  v_add_u32 v5, s30, v4
  s_xor_b32 s31, s3, 1
  s_mul_i32 s31, s31, 17408
  v_add_u32 v6, s31, v4
  v_and_b32 v7, 31, v0
  v_lshlrev_b32 v7, 4, v7
  s_add_u32 s31, s34, 64
  v_add_u32 v7, s31, v7
  v_lshrrev_b32 v8, 5, v0
  s_mov_b32 s8, s54
  s_mov_b32 s9, s55
  s_mov_b32 s10, 0x10000000
  s_mov_b32 s11, 0x00020000
  s_waitcnt lgkmcnt(14)
  v_mfma_f32_32x32x16_bf16 v[96:111], v[32:35], v[36:39], 0
  s_waitcnt lgkmcnt(12)
  v_mfma_f32_32x32x16_bf16 v[96:111], v[40:43], v[44:47], v[96:111]
  s_waitcnt lgkmcnt(10)
  v_mfma_f32_32x32x16_bf16 v[96:111], v[48:51], v[52:55], v[96:111]
  s_waitcnt lgkmcnt(8)
  v_mfma_f32_32x32x16_bf16 v[96:111], v[56:59], v[60:63], v[96:111]
  s_waitcnt lgkmcnt(6)
  v_mfma_f32_32x32x16_bf16 v[96:111], v[64:67], v[68:71], v[96:111]
  s_waitcnt lgkmcnt(4)
  v_mfma_f32_32x32x16_bf16 v[96:111], v[72:75], v[76:79], v[96:111]
  s_waitcnt lgkmcnt(2)
  v_mfma_f32_32x32x16_bf16 v[96:111], v[80:83], v[84:87], v[96:111]
  s_waitcnt lgkmcnt(0)
  v_mfma_f32_32x32x16_bf16 v[96:111], v[88:91], v[92:95], v[96:111]
  s_cmp_eq_u32 s24, 1
  s_cbranch_scc1 k1_mh1
  v_lshl_add_u32 v7, v8, 3, v7
  v_mov_b32 v9, s29
  v_cmp_eq_u32 vcc, 0, v0
  s_nop 1
  v_cndmask_b32 v9, 0, v9, vcc
  s_nop 3
  ds_write_b128 v5, v[104:107]
  ds_write_b128 v5, v[108:111] offset:1024
  s_waitcnt lgkmcnt(0) vmcnt(0)
  s_barrier
  ds_read_b128 v[32:35], v6
  ds_read_b128 v[36:39], v6 offset:1024
  v_add_f32 v96, v96, v9
  s_waitcnt lgkmcnt(1)
  v_pk_add_f32 v[96:97], v[96:97], v[32:33]
  v_pk_add_f32 v[98:99], v[98:99], v[34:35]
  v_cvt_pk_bf16_f32 v10, v96, v97
  v_cvt_pk_bf16_f32 v11, v98, v99
  s_waitcnt lgkmcnt(0)
  ds_write_b64 v7, v[10:11]
  v_pk_add_f32 v[100:101], v[100:101], v[36:37]
  v_add_f32 v102, v102, v38
  v_cvt_pk_bf16_f32 v12, v100, v100
  v_cvt_pk_bf16_f32 v13, v101, v102
  ds_write_b64 v7, v[12:13] offset:512
  v_mov_b32 v2, v112
  v_mov_b32 v3, v113
  v_mov_b32 v4, v114
  v_mov_b32 v5, v115
  v_mov_b32 v6, v116
  v_mov_b32 v7, v117
  s_mov_b32 s24, 0xffff0000
  s_waitcnt vmcnt(0) lgkmcnt(0)
  s_barrier
  v_mov_b32 v60, 142208
  ds_read_b32 v61, v60 offset:16
  s_mov_b32 s37, 0x40000
  s_branch k1_kernel_sc33
k1_kernel_sp31:
  ds_read_b32 v61, v60 offset:16
k1_kernel_sc33:
  s_waitcnt lgkmcnt(0)
  v_cmp_eq_u32 vcc, 0, v61
  s_cbranch_vccz k1_kernel_sd32
  s_sub_u32 s37, s37, 1
  s_cmp_lg_u32 s37, 0
  s_cbranch_scc1 k1_kernel_sp31
k1_kernel_sd32:
k1_kernel_gd30:
  ds_read_b128 v[16:19], v3 offset:0
  ds_read_b64_tr_b16 a[12:13], v4 offset:416
  ds_read_b64_tr_b16 a[14:15], v4 offset:384
  ds_read_b64_tr_b16 a[60:61], v4 offset:1952
  ds_read_b64_tr_b16 a[62:63], v4 offset:1920
  ds_read_b64_tr_b16 a[76:77], v4 offset:2464
  ds_read_b64_tr_b16 a[78:79], v4 offset:2432
  ds_read_b64_tr_b16 a[124:125], v4 offset:4000
  ds_read_b64_tr_b16 a[126:127], v4 offset:3968
  ds_read_b128 v[20:23], v2 offset:512
  ds_read_b64_tr_b16 a[8:9], v4 offset:288
  ds_read_b64_tr_b16 a[10:11], v4 offset:256
  ds_read_b64_tr_b16 a[56:57], v4 offset:1824
  s_waitcnt lgkmcnt(10)
  v_mfma_f32_32x32x16_bf16 v[64:79], a[12:15], v[16:19], 0
  ds_read_b64_tr_b16 a[58:59], v4 offset:1792
  ds_read_b64_tr_b16 a[72:73], v4 offset:2336
  s_waitcnt lgkmcnt(10)
  v_mfma_f32_32x32x16_bf16 v[80:95], a[60:63], v[16:19], 0
  ds_read_b64_tr_b16 a[74:75], v4 offset:2304
  ds_read_b64_tr_b16 a[120:121], v4 offset:3872
  s_waitcnt lgkmcnt(10)
  v_mfma_f32_32x32x16_bf16 v[96:111], a[76:79], v[16:19], 0
  ds_read_b64_tr_b16 a[122:123], v4 offset:3840
  ds_read_b128 v[24:27], v3 offset:1024
  s_waitcnt lgkmcnt(10)
  v_mfma_f32_32x32x16_bf16 v[112:127], a[124:127], v[16:19], 0
  ds_read_b64_tr_b16 a[4:5], v4 offset:160
  ds_read_b64_tr_b16 a[6:7], v4 offset:128
  ds_read_b64_tr_b16 a[52:53], v4 offset:1696
  s_waitcnt lgkmcnt(10)
  v_mfma_f32_32x32x16_bf16 v[64:79], a[8:11], v[20:23], v[64:79]
  ds_read_b64_tr_b16 a[54:55], v4 offset:1664
  ds_read_b64_tr_b16 a[68:69], v4 offset:2208
  s_waitcnt lgkmcnt(10)
  v_mfma_f32_32x32x16_bf16 v[80:95], a[56:59], v[20:23], v[80:95]
  ds_read_b64_tr_b16 a[70:71], v4 offset:2176
  ds_read_b64_tr_b16 a[116:117], v4 offset:3744
  s_waitcnt lgkmcnt(10)
  v_mfma_f32_32x32x16_bf16 v[96:111], a[72:75], v[20:23], v[96:111]
  ds_read_b64_tr_b16 a[118:119], v4 offset:3712
  ds_read_b128 v[28:31], v2 offset:1536
  s_waitcnt lgkmcnt(10)
  v_mfma_f32_32x32x16_bf16 v[112:127], a[120:123], v[20:23], v[112:127]
  ds_read_b64_tr_b16 a[0:1], v4 offset:32
  ds_read_b64_tr_b16 a[2:3], v4 offset:0
  ds_read_b64_tr_b16 a[48:49], v4 offset:1568
  s_waitcnt lgkmcnt(10)
  v_mfma_f32_32x32x16_bf16 v[64:79], a[4:7], v[24:27], v[64:79]
  ds_read_b64_tr_b16 a[50:51], v4 offset:1536
  ds_read_b64_tr_b16 a[64:65], v4 offset:2080
  s_waitcnt lgkmcnt(10)
  v_mfma_f32_32x32x16_bf16 v[80:95], a[52:55], v[24:27], v[80:95]
  ds_read_b64_tr_b16 a[66:67], v4 offset:2048
  ds_read_b64_tr_b16 a[112:113], v4 offset:3616
  s_waitcnt lgkmcnt(10)
  v_mfma_f32_32x32x16_bf16 v[96:111], a[68:71], v[24:27], v[96:111]
  ds_read_b64_tr_b16 a[114:115], v4 offset:3584
  ds_read_b128 v[16:19], v3 offset:2048
  s_waitcnt lgkmcnt(10)
  v_mfma_f32_32x32x16_bf16 v[112:127], a[116:119], v[24:27], v[112:127]
  ds_read_b64_tr_b16 a[44:45], v4 offset:1440
  ds_read_b64_tr_b16 a[46:47], v4 offset:1408
  ds_read_b64_tr_b16 a[108:109], v4 offset:3488
  s_waitcnt lgkmcnt(10)
  v_mfma_f32_32x32x16_bf16 v[64:79], a[0:3], v[28:31], v[64:79]
  ds_read_b64_tr_b16 a[110:111], v4 offset:3456
  ds_read_b32 v61, v60 offset:20
  ds_read_b128 v[20:23], v2 offset:2560
  s_waitcnt lgkmcnt(11)
  v_mfma_f32_32x32x16_bf16 v[80:95], a[48:51], v[28:31], v[80:95]
  ds_read_b64_tr_b16 a[40:41], v4 offset:1312
  ds_read_b64_tr_b16 a[42:43], v4 offset:1280
  s_waitcnt lgkmcnt(11)
  v_mfma_f32_32x32x16_bf16 v[96:111], a[64:67], v[28:31], v[96:111]
  ds_read_b64_tr_b16 a[104:105], v4 offset:3360
  ds_read_b64_tr_b16 a[106:107], v4 offset:3328
  s_waitcnt lgkmcnt(11)
  v_mfma_f32_32x32x16_bf16 v[112:127], a[112:115], v[28:31], v[112:127]
  v_mov_b32 v32, 0
  v_add_f32_dpp v64, v65, v64 row_ror:4 row_mask:0xf bank_mask:0xe
  v_add_f32_dpp v68, v69, v68 row_ror:4 row_mask:0xf bank_mask:0xe
  v_add_f32_dpp v72, v73, v72 row_ror:4 row_mask:0xf bank_mask:0xe
  v_add_f32_dpp v76, v77, v76 row_ror:4 row_mask:0xf bank_mask:0xe
  ds_read_b128 v[24:27], v3 offset:3072
  ds_read_b64_tr_b16 a[36:37], v4 offset:1184
  ds_read_b64_tr_b16 a[38:39], v4 offset:1152
  s_waitcnt lgkmcnt(11)
  v_mfma_f32_32x32x16_bf16 v[80:95], a[44:47], v[16:19], v[80:95]
  v_add_f32_dpp v68, v65, v68 row_ror:4 row_mask:0xf bank_mask:0x1
  v_add_f32_dpp v72, v69, v72 row_ror:4 row_mask:0xf bank_mask:0x1
  v_add_f32_dpp v76, v73, v76 row_ror:4 row_mask:0xf bank_mask:0x1
  v_add_f32_dpp v32, v77, v32 row_ror:4 row_mask:0xf bank_mask:0x1
  v_add_f32_dpp v64, v66, v64 row_ror:8 row_mask:0xf bank_mask:0xc
  v_mfma_f32_32x32x16_bf16 v[96:111], a[60:63], v[16:19], v[96:111]
  v_add_f32_dpp v68, v70, v68 row_ror:8 row_mask:0xf bank_mask:0xc
  v_add_f32_dpp v72, v74, v72 row_ror:8 row_mask:0xf bank_mask:0xc
  v_add_f32_dpp v76, v78, v76 row_ror:8 row_mask:0xf bank_mask:0xc
  v_add_f32_dpp v68, v66, v68 row_ror:8 row_mask:0xf bank_mask:0x3
  v_add_f32_dpp v72, v70, v72 row_ror:8 row_mask:0xf bank_mask:0x3
  ds_read_b64_tr_b16 a[100:101], v4 offset:3232
  ds_read_b64_tr_b16 a[102:103], v4 offset:3200
  s_waitcnt lgkmcnt(11)
  v_mfma_f32_32x32x16_bf16 v[112:127], a[108:111], v[16:19], v[112:127]
  v_add_f32_dpp v76, v74, v76 row_ror:8 row_mask:0xf bank_mask:0x3
  v_add_f32_dpp v32, v78, v32 row_ror:8 row_mask:0xf bank_mask:0x3
  v_add_f32_dpp v64, v67, v64 row_ror:12 row_mask:0xf bank_mask:0x8
  v_add_f32_dpp v68, v71, v68 row_ror:12 row_mask:0xf bank_mask:0x8
  v_add_f32_dpp v72, v75, v72 row_ror:12 row_mask:0xf bank_mask:0x8
  ds_read_b128 v[28:31], v2 offset:3584
  ds_read_b64_tr_b16 a[32:33], v4 offset:1056
  ds_read_b64_tr_b16 a[34:35], v4 offset:1024
  s_waitcnt lgkmcnt(10)
  v_mfma_f32_32x32x16_bf16 v[80:95], a[40:43], v[20:23], v[80:95]
  v_add_f32_dpp v76, v79, v76 row_ror:12 row_mask:0xf bank_mask:0x8
  v_add_f32_dpp v68, v67, v68 row_ror:12 row_mask:0xf bank_mask:0x7
  v_add_f32_dpp v72, v71, v72 row_ror:12 row_mask:0xf bank_mask:0x7
  v_add_f32_dpp v76, v75, v76 row_ror:12 row_mask:0xf bank_mask:0x7
  v_add_f32_dpp v32, v79, v32 row_ror:12 row_mask:0xf bank_mask:0x7
  v_mfma_f32_32x32x16_bf16 v[96:111], a[56:59], v[20:23], v[96:111]
  ds_write_b32 v5, v32 offset:16
  ds_read_b64 v[36:37], v6 offset:0
  ds_read_b64_tr_b16 a[96:97], v4 offset:3104
  ds_read_b64_tr_b16 a[98:99], v4 offset:3072
  s_waitcnt lgkmcnt(12)
  v_mfma_f32_32x32x16_bf16 v[112:127], a[104:107], v[20:23], v[112:127]
  v_cmp_ne_u32 vcc, 0, v61
  s_cbranch_vccnz k1_kernel_gd35
  ds_read_b32 v61, v60 offset:20
  s_mov_b32 s37, 0x40000
  s_branch k1_kernel_sc38
k1_kernel_sp36:
  ds_read_b32 v61, v60 offset:20
k1_kernel_sc38:
  s_waitcnt lgkmcnt(0)
  v_cmp_eq_u32 vcc, 0, v61
  s_cbranch_vccz k1_kernel_sd37
  s_sub_u32 s37, s37, 1
  s_cmp_lg_u32 s37, 0
  s_cbranch_scc1 k1_kernel_sp36
k1_kernel_sd37:
k1_kernel_gd35:
  ds_read_b128 v[16:19], v3 offset:4096
  ds_read_b64_tr_b16 a[28:29], v4 offset:928
  ds_read_b64_tr_b16 a[30:31], v4 offset:896
  s_waitcnt lgkmcnt(12)
  v_mfma_f32_32x32x16_bf16 v[80:95], a[36:39], v[24:27], v[80:95]
  v_mfma_f32_32x32x16_bf16 v[96:111], a[52:55], v[24:27], v[96:111]
  ds_read_b64_tr_b16 a[92:93], v4 offset:2976
  ds_read_b64_tr_b16 a[94:95], v4 offset:2944
  s_waitcnt lgkmcnt(12)
  v_mfma_f32_32x32x16_bf16 v[112:127], a[100:103], v[24:27], v[112:127]
  ds_read_b128 v[20:23], v2 offset:4608
  ds_read_b64_tr_b16 a[24:25], v4 offset:800
  ds_read_b64_tr_b16 a[26:27], v4 offset:768
  s_waitcnt lgkmcnt(12)
  v_mfma_f32_32x32x16_bf16 v[80:95], a[32:35], v[28:31], v[80:95]
  v_mfma_f32_32x32x16_bf16 v[96:111], a[48:51], v[28:31], v[96:111]
  ds_read_b64_tr_b16 a[88:89], v4 offset:2848
  ds_read_b64_tr_b16 a[90:91], v4 offset:2816
  s_waitcnt lgkmcnt(10)
  v_mfma_f32_32x32x16_bf16 v[112:127], a[96:99], v[28:31], v[112:127]
  ds_read_b128 v[24:27], v3 offset:5120
  ds_read_b64_tr_b16 a[20:21], v4 offset:672
  ds_read_b64_tr_b16 a[22:23], v4 offset:640
  s_waitcnt lgkmcnt(10)
  v_mfma_f32_32x32x16_bf16 v[80:95], a[28:31], v[16:19], v[80:95]
  v_mfma_f32_32x32x16_bf16 v[96:111], a[44:47], v[16:19], v[96:111]
  ds_read_b64_tr_b16 a[84:85], v4 offset:2720
  ds_read_b64_tr_b16 a[86:87], v4 offset:2688
  s_waitcnt lgkmcnt(10)
  v_mfma_f32_32x32x16_bf16 v[112:127], a[92:95], v[16:19], v[112:127]
  ds_read_b128 v[28:31], v2 offset:5632
  ds_read_b64_tr_b16 a[16:17], v4 offset:544
  ds_read_b64_tr_b16 a[18:19], v4 offset:512
  s_waitcnt lgkmcnt(10)
  v_mfma_f32_32x32x16_bf16 v[80:95], a[24:27], v[20:23], v[80:95]
  v_mfma_f32_32x32x16_bf16 v[96:111], a[40:43], v[20:23], v[96:111]
  ds_read_b64_tr_b16 a[80:81], v4 offset:2592
  ds_read_b64_tr_b16 a[82:83], v4 offset:2560
  s_waitcnt lgkmcnt(10)
  v_mfma_f32_32x32x16_bf16 v[112:127], a[88:91], v[20:23], v[112:127]
  ds_read_b128 v[16:19], v3 offset:6144
  ds_read_b32 v61, v60 offset:24
  ds_read_b128 v[20:23], v2 offset:6656
  s_waitcnt lgkmcnt(10)
  v_mfma_f32_32x32x16_bf16 v[80:95], a[20:23], v[24:27], v[80:95]
  v_mfma_f32_32x32x16_bf16 v[96:111], a[36:39], v[24:27], v[96:111]
  s_waitcnt lgkmcnt(8)
  v_mfma_f32_32x32x16_bf16 v[112:127], a[84:87], v[24:27], v[112:127]
  ds_read_b128 v[24:27], v3 offset:7168
  s_waitcnt lgkmcnt(6)
  v_mfma_f32_32x32x16_bf16 v[80:95], a[16:19], v[28:31], v[80:95]
  v_mfma_f32_32x32x16_bf16 v[96:111], a[32:35], v[28:31], v[96:111]
  s_waitcnt lgkmcnt(4)
  v_mfma_f32_32x32x16_bf16 v[112:127], a[80:83], v[28:31], v[112:127]
  ds_read_b128 v[28:31], v2 offset:7680
  s_waitcnt lgkmcnt(4)
  v_mfma_f32_32x32x16_bf16 v[80:95], a[12:15], v[16:19], v[80:95]
  v_mfma_f32_32x32x16_bf16 v[96:111], a[28:31], v[16:19], v[96:111]
  v_mfma_f32_32x32x16_bf16 v[112:127], a[76:79], v[16:19], v[112:127]
  s_waitcnt lgkmcnt(3)
  v_cmp_ne_u32 vcc, 0, v61
  s_cbranch_vccnz k1_kernel_gd40
  ds_read_b32 v61, v60 offset:24
  s_mov_b32 s37, 0x40000
  s_branch k1_kernel_sc43
k1_kernel_sp41:
  ds_read_b32 v61, v60 offset:24
k1_kernel_sc43:
  s_waitcnt lgkmcnt(0)
  v_cmp_eq_u32 vcc, 0, v61
  s_cbranch_vccz k1_kernel_sd42
  s_sub_u32 s37, s37, 1
  s_cmp_lg_u32 s37, 0
  s_cbranch_scc1 k1_kernel_sp41
k1_kernel_sd42:
k1_kernel_gd40:
  ds_read_b128 v[16:19], v3 offset:8192
  s_waitcnt lgkmcnt(3)
  v_mfma_f32_32x32x16_bf16 v[80:95], a[8:11], v[20:23], v[80:95]
  v_mfma_f32_32x32x16_bf16 v[96:111], a[24:27], v[20:23], v[96:111]
  v_mfma_f32_32x32x16_bf16 v[112:127], a[72:75], v[20:23], v[112:127]
  ds_read_b128 v[20:23], v2 offset:8704
  s_waitcnt lgkmcnt(3)
  v_mfma_f32_32x32x16_bf16 v[80:95], a[4:7], v[24:27], v[80:95]
  v_mfma_f32_32x32x16_bf16 v[96:111], a[20:23], v[24:27], v[96:111]
  v_mfma_f32_32x32x16_bf16 v[112:127], a[68:71], v[24:27], v[112:127]
  ds_read_b128 v[24:27], v3 offset:9216
  s_waitcnt lgkmcnt(3)
  v_mfma_f32_32x32x16_bf16 v[80:95], a[0:3], v[28:31], v[80:95]
  v_mfma_f32_32x32x16_bf16 v[96:111], a[16:19], v[28:31], v[96:111]
  v_mfma_f32_32x32x16_bf16 v[112:127], a[64:67], v[28:31], v[112:127]
  ds_read_b128 v[28:31], v2 offset:9728
  s_waitcnt lgkmcnt(3)
  v_mfma_f32_32x32x16_bf16 v[96:111], a[12:15], v[16:19], v[96:111]
  v_mov_b32 v33, 0
  s_nop 5
  v_add_f32_dpp v80, v81, v80 row_ror:4 row_mask:0xf bank_mask:0xe
  v_add_f32_dpp v84, v85, v84 row_ror:4 row_mask:0xf bank_mask:0xe
  v_add_f32_dpp v88, v89, v88 row_ror:4 row_mask:0xf bank_mask:0xe
  v_add_f32_dpp v92, v93, v92 row_ror:4 row_mask:0xf bank_mask:0xe
  v_mfma_f32_32x32x16_bf16 v[112:127], a[60:63], v[16:19], v[112:127]
  v_add_f32_dpp v84, v81, v84 row_ror:4 row_mask:0xf bank_mask:0x1
  v_add_f32_dpp v88, v85, v88 row_ror:4 row_mask:0xf bank_mask:0x1
  v_add_f32_dpp v92, v89, v92 row_ror:4 row_mask:0xf bank_mask:0x1
  v_add_f32_dpp v33, v93, v33 row_ror:4 row_mask:0xf bank_mask:0x1
  v_add_f32_dpp v80, v82, v80 row_ror:8 row_mask:0xf bank_mask:0xc
  ds_read_b128 v[16:19], v3 offset:10240
  s_waitcnt lgkmcnt(3)
  v_mfma_f32_32x32x16_bf16 v[96:111], a[8:11], v[20:23], v[96:111]
  v_add_f32_dpp v84, v86, v84 row_ror:8 row_mask:0xf bank_mask:0xc
  v_add_f32_dpp v88, v90, v88 row_ror:8 row_mask:0xf bank_mask:0xc
  v_add_f32_dpp v92, v94, v92 row_ror:8 row_mask:0xf bank_mask:0xc
  v_add_f32_dpp v84, v82, v84 row_ror:8 row_mask:0xf bank_mask:0x3
  v_add_f32_dpp v88, v86, v88 row_ror:8 row_mask:0xf bank_mask:0x3
  v_mfma_f32_32x32x16_bf16 v[112:127], a[56:59], v[20:23], v[112:127]
  v_add_f32_dpp v92, v90, v92 row_ror:8 row_mask:0xf bank_mask:0x3
  v_add_f32_dpp v33, v94, v33 row_ror:8 row_mask:0xf bank_mask:0x3
  v_add_f32_dpp v80, v83, v80 row_ror:12 row_mask:0xf bank_mask:0x8
  v_add_f32_dpp v84, v87, v84 row_ror:12 row_mask:0xf bank_mask:0x8
  v_add_f32_dpp v88, v91, v88 row_ror:12 row_mask:0xf bank_mask:0x8
  ds_read_b32 v61, v60 offset:28
  ds_read_b128 v[20:23], v2 offset:10752
  s_waitcnt lgkmcnt(4)
  v_mfma_f32_32x32x16_bf16 v[96:111], a[4:7], v[24:27], v[96:111]
  v_add_f32_dpp v92, v95, v92 row_ror:12 row_mask:0xf bank_mask:0x8
  v_add_f32_dpp v84, v83, v84 row_ror:12 row_mask:0xf bank_mask:0x7
  v_add_f32_dpp v88, v87, v88 row_ror:12 row_mask:0xf bank_mask:0x7
  v_add_f32_dpp v92, v91, v92 row_ror:12 row_mask:0xf bank_mask:0x7
  v_add_f32_dpp v33, v95, v33 row_ror:12 row_mask:0xf bank_mask:0x7
  v_mfma_f32_32x32x16_bf16 v[112:127], a[52:55], v[24:27], v[112:127]
  ds_write_b32 v5, v33 offset:784
  ds_read_b64 v[38:39], v6 offset:6144
  ds_read_b128 v[24:27], v3 offset:11264
  s_waitcnt lgkmcnt(6)
  v_mfma_f32_32x32x16_bf16 v[96:111], a[0:3], v[28:31], v[96:111]
  v_mfma_f32_32x32x16_bf16 v[112:127], a[48:51], v[28:31], v[112:127]
  ds_read_b128 v[28:31], v2 offset:11776
  s_waitcnt lgkmcnt(6)
  v_mfma_f32_32x32x16_bf16 v[112:127], a[44:47], v[16:19], v[112:127]
  s_waitcnt lgkmcnt(5)
  v_cmp_ne_u32 vcc, 0, v61
  s_cbranch_vccnz k1_kernel_gd45
  ds_read_b32 v61, v60 offset:28
  s_mov_b32 s37, 0x40000
  s_branch k1_kernel_sc48
k1_kernel_sp46:
  ds_read_b32 v61, v60 offset:28
k1_kernel_sc48:
  s_waitcnt lgkmcnt(0)
  v_cmp_eq_u32 vcc, 0, v61
  s_cbranch_vccz k1_kernel_sd47
  s_sub_u32 s37, s37, 1
  s_cmp_lg_u32 s37, 0
  s_cbranch_scc1 k1_kernel_sp46
k1_kernel_sd47:
k1_kernel_gd45:
  ds_read_b128 v[16:19], v3 offset:12288
  s_waitcnt lgkmcnt(5)
  v_mfma_f32_32x32x16_bf16 v[112:127], a[40:43], v[20:23], v[112:127]
  v_mov_b32 v34, 0
  s_nop 0
  v_add_f32_dpp v96, v97, v96 row_ror:4 row_mask:0xf bank_mask:0xe
  v_add_f32_dpp v100, v101, v100 row_ror:4 row_mask:0xf bank_mask:0xe
  v_add_f32_dpp v104, v105, v104 row_ror:4 row_mask:0xf bank_mask:0xe
  v_add_f32_dpp v108, v109, v108 row_ror:4 row_mask:0xf bank_mask:0xe
  ds_read_b128 v[20:23], v2 offset:12800
  s_waitcnt lgkmcnt(3)
  v_mfma_f32_32x32x16_bf16 v[112:127], a[36:39], v[24:27], v[112:127]
  v_add_f32_dpp v100, v97, v100 row_ror:4 row_mask:0xf bank_mask:0x1
  v_add_f32_dpp v104, v101, v104 row_ror:4 row_mask:0xf bank_mask:0x1
  v_add_f32_dpp v108, v105, v108 row_ror:4 row_mask:0xf bank_mask:0x1
  v_add_f32_dpp v34, v109, v34 row_ror:4 row_mask:0xf bank_mask:0x1
  v_add_f32_dpp v96, v98, v96 row_ror:8 row_mask:0xf bank_mask:0xc
  ds_read_b128 v[24:27], v3 offset:13312
  s_waitcnt lgkmcnt(3)
  v_mfma_f32_32x32x16_bf16 v[112:127], a[32:35], v[28:31], v[112:127]
  v_add_f32_dpp v100, v102, v100 row_ror:8 row_mask:0xf bank_mask:0xc
  v_add_f32_dpp v104, v106, v104 row_ror:8 row_mask:0xf bank_mask:0xc
  v_add_f32_dpp v108, v110, v108 row_ror:8 row_mask:0xf bank_mask:0xc
  v_add_f32_dpp v100, v98, v100 row_ror:8 row_mask:0xf bank_mask:0x3
  v_add_f32_dpp v104, v102, v104 row_ror:8 row_mask:0xf bank_mask:0x3
  ds_read_b128 v[28:31], v2 offset:13824
  s_waitcnt lgkmcnt(3)
  v_mfma_f32_32x32x16_bf16 v[112:127], a[28:31], v[16:19], v[112:127]
  v_add_f32_dpp v108, v106, v108 row_ror:8 row_mask:0xf bank_mask:0x3
  v_add_f32_dpp v34, v110, v34 row_ror:8 row_mask:0xf bank_mask:0x3
  v_add_f32_dpp v96, v99, v96 row_ror:12 row_mask:0xf bank_mask:0x8
  v_add_f32_dpp v100, v103, v100 row_ror:12 row_mask:0xf bank_mask:0x8
  v_add_f32_dpp v104, v107, v104 row_ror:12 row_mask:0xf bank_mask:0x8
  ds_read_b128 v[16:19], v3 offset:14336
  s_waitcnt lgkmcnt(3)
  v_mfma_f32_32x32x16_bf16 v[112:127], a[24:27], v[20:23], v[112:127]
  v_add_f32_dpp v108, v111, v108 row_ror:12 row_mask:0xf bank_mask:0x8
  v_add_f32_dpp v100, v99, v100 row_ror:12 row_mask:0xf bank_mask:0x7
  v_add_f32_dpp v104, v103, v104 row_ror:12 row_mask:0xf bank_mask:0x7
  v_add_f32_dpp v108, v107, v108 row_ror:12 row_mask:0xf bank_mask:0x7
  v_add_f32_dpp v34, v111, v34 row_ror:12 row_mask:0xf bank_mask:0x7
  ds_read_b128 v[20:23], v2 offset:14848
  s_waitcnt lgkmcnt(3)
  v_mfma_f32_32x32x16_bf16 v[112:127], a[20:23], v[24:27], v[112:127]
  ds_write_b32 v5, v34 offset:1040
  ds_read_b64 v[40:41], v6 offset:8192
  ds_read_b128 v[24:27], v3 offset:15360
  s_waitcnt lgkmcnt(5)
  v_mfma_f32_32x32x16_bf16 v[112:127], a[16:19], v[28:31], v[112:127]
  ds_read_b128 v[28:31], v2 offset:15872
  s_waitcnt lgkmcnt(5)
  v_mfma_f32_32x32x16_bf16 v[112:127], a[12:15], v[16:19], v[112:127]
  s_waitcnt lgkmcnt(4)
  v_mfma_f32_32x32x16_bf16 v[112:127], a[8:11], v[20:23], v[112:127]
  s_waitcnt lgkmcnt(1)
  v_mfma_f32_32x32x16_bf16 v[112:127], a[4:7], v[24:27], v[112:127]
  s_waitcnt lgkmcnt(0)
  v_mfma_f32_32x32x16_bf16 v[112:127], a[0:3], v[28:31], v[112:127]
  v_mov_b32 v35, 0
  s_nop 7
  s_nop 2
  v_add_f32_dpp v112, v113, v112 row_ror:4 row_mask:0xf bank_mask:0xe
  v_add_f32_dpp v116, v117, v116 row_ror:4 row_mask:0xf bank_mask:0xe
  v_add_f32_dpp v120, v121, v120 row_ror:4 row_mask:0xf bank_mask:0xe
  v_add_f32_dpp v124, v125, v124 row_ror:4 row_mask:0xf bank_mask:0xe
  v_add_f32_dpp v116, v113, v116 row_ror:4 row_mask:0xf bank_mask:0x1
  v_add_f32_dpp v120, v117, v120 row_ror:4 row_mask:0xf bank_mask:0x1
  v_add_f32_dpp v124, v121, v124 row_ror:4 row_mask:0xf bank_mask:0x1
  v_add_f32_dpp v35, v125, v35 row_ror:4 row_mask:0xf bank_mask:0x1
  v_add_f32_dpp v112, v114, v112 row_ror:8 row_mask:0xf bank_mask:0xc
  v_add_f32_dpp v116, v118, v116 row_ror:8 row_mask:0xf bank_mask:0xc
  v_add_f32_dpp v120, v122, v120 row_ror:8 row_mask:0xf bank_mask:0xc
  v_add_f32_dpp v124, v126, v124 row_ror:8 row_mask:0xf bank_mask:0xc
  v_add_f32_dpp v116, v114, v116 row_ror:8 row_mask:0xf bank_mask:0x3
  v_add_f32_dpp v120, v118, v120 row_ror:8 row_mask:0xf bank_mask:0x3
  v_add_f32_dpp v124, v122, v124 row_ror:8 row_mask:0xf bank_mask:0x3
  v_add_f32_dpp v35, v126, v35 row_ror:8 row_mask:0xf bank_mask:0x3
  v_add_f32_dpp v112, v115, v112 row_ror:12 row_mask:0xf bank_mask:0x8
  v_add_f32_dpp v116, v119, v116 row_ror:12 row_mask:0xf bank_mask:0x8
  v_add_f32_dpp v120, v123, v120 row_ror:12 row_mask:0xf bank_mask:0x8
  v_add_f32_dpp v124, v127, v124 row_ror:12 row_mask:0xf bank_mask:0x8
  v_add_f32_dpp v116, v115, v116 row_ror:12 row_mask:0xf bank_mask:0x7
  v_add_f32_dpp v120, v119, v120 row_ror:12 row_mask:0xf bank_mask:0x7
  v_add_f32_dpp v124, v123, v124 row_ror:12 row_mask:0xf bank_mask:0x7
  v_add_f32_dpp v35, v127, v35 row_ror:12 row_mask:0xf bank_mask:0x7
  ds_write_b32 v5, v35 offset:1808
  ds_read_b64 v[42:43], v6 offset:14336
  s_waitcnt lgkmcnt(0)
  s_barrier
  ds_read_b32 v32, v5 offset:0
  ds_read_b32 v33, v5 offset:768
  ds_read_b32 v34, v5 offset:1024
  ds_read_b32 v35, v5 offset:1792
  v_lshlrev_b32 v44, 16, v36
  v_and_b32 v45, s24, v36
  v_lshlrev_b32 v46, 16, v37
  v_and_b32 v47, s24, v37
  v_add_f32 v44, v44, v64
  v_add_f32 v45, v45, v68
  v_add_f32 v46, v46, v72
  v_add_f32 v47, v47, v76
  v_cvt_pk_bf16_f32 v37, v46, v47
  v_lshlrev_b32 v48, 16, v38
  v_and_b32 v49, s24, v38
  v_lshlrev_b32 v50, 16, v39
  v_and_b32 v51, s24, v39
  v_add_f32 v48, v48, v80
  v_add_f32 v49, v49, v84
  v_add_f32 v50, v50, v88
  v_add_f32 v51, v51, v92
  v_cvt_pk_bf16_f32 v39, v50, v51
  v_lshlrev_b32 v52, 16, v40
  v_and_b32 v53, s24, v40
  v_lshlrev_b32 v54, 16, v41
  v_and_b32 v55, s24, v41
  v_add_f32 v52, v52, v96
  v_add_f32 v53, v53, v100
  v_add_f32 v54, v54, v104
  v_add_f32 v55, v55, v108
  v_cvt_pk_bf16_f32 v41, v54, v55
  v_lshlrev_b32 v56, 16, v42
  v_and_b32 v57, s24, v42
  v_lshlrev_b32 v58, 16, v43
  v_and_b32 v59, s24, v43
  v_add_f32 v56, v56, v112
  v_add_f32 v57, v57, v116
  v_add_f32 v58, v58, v120
  v_add_f32 v59, v59, v124
  v_cvt_pk_bf16_f32 v43, v58, v59
  s_waitcnt lgkmcnt(3)
  v_add_f32 v44, v44, v32
  v_cvt_pk_bf16_f32 v36, v44, v45
  s_mov_b32 s25, 6291456
  buffer_store_dwordx2 v[36:37], v7, s[8:11], s25 offen sc1
  s_waitcnt lgkmcnt(2)
  v_add_f32 v48, v48, v33
  v_cvt_pk_bf16_f32 v38, v48, v49
  s_mov_b32 s25, 7077888
  buffer_store_dwordx2 v[38:39], v7, s[8:11], s25 offen sc1
  s_waitcnt lgkmcnt(1)
  v_add_f32 v52, v52, v34
  v_cvt_pk_bf16_f32 v40, v52, v53
  s_mov_b32 s25, 7340032
  buffer_store_dwordx2 v[40:41], v7, s[8:11], s25 offen sc1
  s_waitcnt lgkmcnt(0)
  v_add_f32 v56, v56, v35
  v_cvt_pk_bf16_f32 v42, v56, v57
  s_mov_b32 s25, 8126464
  buffer_store_dwordx2 v[42:43], v7, s[8:11], s25 offen sc1
  s_endpgm
k1_mh1:
  v_lshl_add_u32 v9, v8, 10, v7
  v_lshl_add_u32 v7, v8, 9, v7
  s_mov_b32 vcc_lo, 0xaaaaaaaa
  s_mov_b32 vcc_hi, 0xaaaaaaaa
  s_nop 5
  ds_write_b128 v5, v[96:99]
  ds_write_b128 v5, v[100:103] offset:1024
  s_waitcnt lgkmcnt(0) vmcnt(0)
  s_barrier
  ds_read_b128 v[32:35], v6
  ds_read_b128 v[36:39], v6 offset:1024
  s_waitcnt lgkmcnt(1)
  v_pk_add_f32 v[104:105], v[104:105], v[32:33]
  v_add_f32 v106, v106, v34
  v_cvt_pk_bf16_f32 v12, v104, v104
  v_cvt_pk_bf16_f32 v13, v104, v105
  v_cvt_pk_bf16_f32 v14, v105, v105
  v_cvt_pk_bf16_f32 v15, v106, v106
  s_waitcnt lgkmcnt(0)
  ds_write_b128 v7, v[12:15] offset:1024
  v_pk_add_f32 v[108:109], v[108:109], v[36:37]
  v_pk_add_f32 v[110:111], v[110:111], v[38:39]
  v_cndmask_b32 v24, v108, v109, vcc
  v_cndmask_b32 v25, v110, v111, vcc
  v_cvt_pk_bf16_f32 v16, v108, v108
  v_cvt_pk_bf16_f32 v17, v108, v108
  v_cvt_pk_bf16_f32 v18, v24, v109
  v_cvt_pk_bf16_f32 v19, v109, v109
  v_cvt_pk_bf16_f32 v20, v110, v110
  v_cvt_pk_bf16_f32 v21, v110, v110
  v_cvt_pk_bf16_f32 v22, v25, v111
  v_cvt_pk_bf16_f32 v23, v111, v111
  ds_write_b128 v9, v[16:19] offset:2048
  ds_write_b128 v9, v[20:23] offset:2560
  v_mov_b32 v2, v112
  v_mov_b32 v3, v113
  v_mov_b32 v4, v114
  v_mov_b32 v5, v115
  v_mov_b32 v6, v116
  v_mov_b32 v7, v117
  s_mov_b32 s24, 0xffff0000
  s_waitcnt vmcnt(0) lgkmcnt(0)
  s_barrier
  v_mov_b32 v60, 142208
  ds_read_b32 v61, v60 offset:16
  s_mov_b32 s37, 0x40000
  s_branch k1_kernel_sc53
k1_kernel_sp51:
  ds_read_b32 v61, v60 offset:16
k1_kernel_sc53:
  s_waitcnt lgkmcnt(0)
  v_cmp_eq_u32 vcc, 0, v61
  s_cbranch_vccz k1_kernel_sd52
  s_sub_u32 s37, s37, 1
  s_cmp_lg_u32 s37, 0
  s_cbranch_scc1 k1_kernel_sp51
k1_kernel_sd52:
k1_kernel_gd50:
  ds_read_b128 v[16:19], v3 offset:0
  ds_read_b64_tr_b16 a[28:29], v4 offset:928
  ds_read_b64_tr_b16 a[30:31], v4 offset:896
  ds_read_b64_tr_b16 a[44:45], v4 offset:1440
  ds_read_b64_tr_b16 a[46:47], v4 offset:1408
  ds_read_b64_tr_b16 a[92:93], v4 offset:2976
  ds_read_b64_tr_b16 a[94:95], v4 offset:2944
  ds_read_b64_tr_b16 a[108:109], v4 offset:3488
  ds_read_b64_tr_b16 a[110:111], v4 offset:3456
  ds_read_b128 v[20:23], v2 offset:512
  ds_read_b64_tr_b16 a[24:25], v4 offset:800
  ds_read_b64_tr_b16 a[26:27], v4 offset:768
  ds_read_b64_tr_b16 a[40:41], v4 offset:1312
  s_waitcnt lgkmcnt(10)
  v_mfma_f32_32x32x16_bf16 v[64:79], a[28:31], v[16:19], 0
  ds_read_b64_tr_b16 a[42:43], v4 offset:1280
  ds_read_b64_tr_b16 a[88:89], v4 offset:2848
  s_waitcnt lgkmcnt(10)
  v_mfma_f32_32x32x16_bf16 v[80:95], a[44:47], v[16:19], 0
  ds_read_b64_tr_b16 a[90:91], v4 offset:2816
  ds_read_b64_tr_b16 a[104:105], v4 offset:3360
  s_waitcnt lgkmcnt(10)
  v_mfma_f32_32x32x16_bf16 v[96:111], a[92:95], v[16:19], 0
  ds_read_b64_tr_b16 a[106:107], v4 offset:3328
  ds_read_b128 v[24:27], v3 offset:1024
  s_waitcnt lgkmcnt(10)
  v_mfma_f32_32x32x16_bf16 v[112:127], a[108:111], v[16:19], 0
  ds_read_b64_tr_b16 a[20:21], v4 offset:672
  ds_read_b64_tr_b16 a[22:23], v4 offset:640
  ds_read_b64_tr_b16 a[36:37], v4 offset:1184
  s_waitcnt lgkmcnt(10)
  v_mfma_f32_32x32x16_bf16 v[64:79], a[24:27], v[20:23], v[64:79]
  ds_read_b64_tr_b16 a[38:39], v4 offset:1152
  ds_read_b64_tr_b16 a[84:85], v4 offset:2720
  s_waitcnt lgkmcnt(10)
  v_mfma_f32_32x32x16_bf16 v[80:95], a[40:43], v[20:23], v[80:95]
  ds_read_b64_tr_b16 a[86:87], v4 offset:2688
  ds_read_b64_tr_b16 a[100:101], v4 offset:3232
  s_waitcnt lgkmcnt(10)
  v_mfma_f32_32x32x16_bf16 v[96:111], a[88:91], v[20:23], v[96:111]
  ds_read_b64_tr_b16 a[102:103], v4 offset:3200
  ds_read_b128 v[28:31], v2 offset:1536
  s_waitcnt lgkmcnt(10)
  v_mfma_f32_32x32x16_bf16 v[112:127], a[104:107], v[20:23], v[112:127]
  ds_read_b64_tr_b16 a[16:17], v4 offset:544
  ds_read_b64_tr_b16 a[18:19], v4 offset:512
  ds_read_b64_tr_b16 a[32:33], v4 offset:1056
  s_waitcnt lgkmcnt(10)
  v_mfma_f32_32x32x16_bf16 v[64:79], a[20:23], v[24:27], v[64:79]
  ds_read_b64_tr_b16 a[34:35], v4 offset:1024
  ds_read_b64_tr_b16 a[80:81], v4 offset:2592
  s_waitcnt lgkmcnt(10)
  v_mfma_f32_32x32x16_bf16 v[80:95], a[36:39], v[24:27], v[80:95]
  ds_read_b64_tr_b16 a[82:83], v4 offset:2560
  ds_read_b64_tr_b16 a[96:97], v4 offset:3104
  s_waitcnt lgkmcnt(10)
  v_mfma_f32_32x32x16_bf16 v[96:111], a[84:87], v[24:27], v[96:111]
  ds_read_b64_tr_b16 a[98:99], v4 offset:3072
  ds_read_b128 v[16:19], v3 offset:2048
  s_waitcnt lgkmcnt(10)
  v_mfma_f32_32x32x16_bf16 v[112:127], a[100:103], v[24:27], v[112:127]
  ds_read_b64_tr_b16 a[12:13], v4 offset:416
  ds_read_b64_tr_b16 a[14:15], v4 offset:384
  ds_read_b64_tr_b16 a[76:77], v4 offset:2464
  s_waitcnt lgkmcnt(10)
  v_mfma_f32_32x32x16_bf16 v[64:79], a[16:19], v[28:31], v[64:79]
  ds_read_b64_tr_b16 a[78:79], v4 offset:2432
  ds_read_b32 v61, v60 offset:20
  ds_read_b128 v[20:23], v2 offset:2560
  s_waitcnt lgkmcnt(11)
  v_mfma_f32_32x32x16_bf16 v[80:95], a[32:35], v[28:31], v[80:95]
  ds_read_b64_tr_b16 a[8:9], v4 offset:288
  ds_read_b64_tr_b16 a[10:11], v4 offset:256
  s_waitcnt lgkmcnt(11)
  v_mfma_f32_32x32x16_bf16 v[96:111], a[80:83], v[28:31], v[96:111]
  ds_read_b64_tr_b16 a[72:73], v4 offset:2336
  ds_read_b64_tr_b16 a[74:75], v4 offset:2304
  s_waitcnt lgkmcnt(11)
  v_mfma_f32_32x32x16_bf16 v[112:127], a[96:99], v[28:31], v[112:127]
  ds_read_b128 v[24:27], v3 offset:3072
  ds_read_b64_tr_b16 a[4:5], v4 offset:160
  ds_read_b64_tr_b16 a[6:7], v4 offset:128
  s_waitcnt lgkmcnt(11)
  v_mfma_f32_32x32x16_bf16 v[64:79], a[12:15], v[16:19], v[64:79]
  v_mfma_f32_32x32x16_bf16 v[80:95], a[28:31], v[16:19], v[80:95]
  ds_read_b64_tr_b16 a[68:69], v4 offset:2208
  ds_read_b64_tr_b16 a[70:71], v4 offset:2176
  s_waitcnt lgkmcnt(11)
  v_mfma_f32_32x32x16_bf16 v[96:111], a[76:79], v[16:19], v[96:111]
  v_mfma_f32_32x32x16_bf16 v[112:127], a[92:95], v[16:19], v[112:127]
  ds_read_b128 v[28:31], v2 offset:3584
  ds_read_b64_tr_b16 a[0:1], v4 offset:32
  ds_read_b64_tr_b16 a[2:3], v4 offset:0
  s_waitcnt lgkmcnt(10)
  v_mfma_f32_32x32x16_bf16 v[64:79], a[8:11], v[20:23], v[64:79]
  v_mfma_f32_32x32x16_bf16 v[80:95], a[24:27], v[20:23], v[80:95]
  ds_read_b64_tr_b16 a[64:65], v4 offset:2080
  ds_read_b64_tr_b16 a[66:67], v4 offset:2048
  s_waitcnt lgkmcnt(10)
  v_mfma_f32_32x32x16_bf16 v[96:111], a[72:75], v[20:23], v[96:111]
  v_mfma_f32_32x32x16_bf16 v[112:127], a[88:91], v[20:23], v[112:127]
  v_cmp_ne_u32 vcc, 0, v61
  s_cbranch_vccnz k1_kernel_gd55
  ds_read_b32 v61, v60 offset:20
  s_mov_b32 s37, 0x40000
  s_branch k1_kernel_sc58
k1_kernel_sp56:
  ds_read_b32 v61, v60 offset:20
k1_kernel_sc58:
  s_waitcnt lgkmcnt(0)
  v_cmp_eq_u32 vcc, 0, v61
  s_cbranch_vccz k1_kernel_sd57
  s_sub_u32 s37, s37, 1
  s_cmp_lg_u32 s37, 0
  s_cbranch_scc1 k1_kernel_sp56
k1_kernel_sd57:
k1_kernel_gd55:
  ds_read_b128 v[16:19], v3 offset:4096
  ds_read_b64_tr_b16 a[60:61], v4 offset:1952
  ds_read_b64_tr_b16 a[62:63], v4 offset:1920
  s_waitcnt lgkmcnt(10)
  v_mfma_f32_32x32x16_bf16 v[64:79], a[4:7], v[24:27], v[64:79]
  v_mfma_f32_32x32x16_bf16 v[80:95], a[20:23], v[24:27], v[80:95]
  ds_read_b128 v[20:23], v2 offset:4608
  ds_read_b64_tr_b16 a[56:57], v4 offset:1824
  s_waitcnt lgkmcnt(10)
  v_mfma_f32_32x32x16_bf16 v[96:111], a[68:71], v[24:27], v[96:111]
  v_mfma_f32_32x32x16_bf16 v[112:127], a[84:87], v[24:27], v[112:127]
  ds_read_b64_tr_b16 a[58:59], v4 offset:1792
  ds_read_b128 v[24:27], v3 offset:5120
  ds_read_b64_tr_b16 a[52:53], v4 offset:1696
  s_waitcnt lgkmcnt(10)
  v_mfma_f32_32x32x16_bf16 v[64:79], a[0:3], v[28:31], v[64:79]
  v_mfma_f32_32x32x16_bf16 v[80:95], a[16:19], v[28:31], v[80:95]
  ds_read_b64_tr_b16 a[54:55], v4 offset:1664
  s_waitcnt lgkmcnt(9)
  v_mfma_f32_32x32x16_bf16 v[96:111], a[64:67], v[28:31], v[96:111]
  v_mfma_f32_32x32x16_bf16 v[112:127], a[80:83], v[28:31], v[112:127]
  v_mov_b32 v32, 0
  s_nop 5
  v_add_f32_dpp v64, v65, v64 row_ror:4 row_mask:0xf bank_mask:0xe
  v_add_f32_dpp v68, v69, v68 row_ror:4 row_mask:0xf bank_mask:0xe
  v_add_f32_dpp v72, v73, v72 row_ror:4 row_mask:0xf bank_mask:0xe
  v_add_f32_dpp v76, v77, v76 row_ror:4 row_mask:0xf bank_mask:0xe
  ds_read_b128 v[28:31], v2 offset:5632
  ds_read_b64_tr_b16 a[48:49], v4 offset:1568
  s_waitcnt lgkmcnt(10)
  v_mfma_f32_32x32x16_bf16 v[80:95], a[12:15], v[16:19], v[80:95]
  v_add_f32_dpp v68, v65, v68 row_ror:4 row_mask:0xf bank_mask:0x1
  v_add_f32_dpp v72, v69, v72 row_ror:4 row_mask:0xf bank_mask:0x1
  v_add_f32_dpp v76, v73, v76 row_ror:4 row_mask:0xf bank_mask:0x1
  v_add_f32_dpp v32, v77, v32 row_ror:4 row_mask:0xf bank_mask:0x1
  v_add_f32_dpp v64, v66, v64 row_ror:8 row_mask:0xf bank_mask:0xc
  ds_read_b64_tr_b16 a[50:51], v4 offset:1536
  s_waitcnt lgkmcnt(9)
  v_mfma_f32_32x32x16_bf16 v[96:111], a[60:63], v[16:19], v[96:111]
  v_add_f32_dpp v68, v70, v68 row_ror:8 row_mask:0xf bank_mask:0xc
  v_add_f32_dpp v72, v74, v72 row_ror:8 row_mask:0xf bank_mask:0xc
  v_add_f32_dpp v76, v78, v76 row_ror:8 row_mask:0xf bank_mask:0xc
  v_add_f32_dpp v68, v66, v68 row_ror:8 row_mask:0xf bank_mask:0x3
  v_add_f32_dpp v72, v70, v72 row_ror:8 row_mask:0xf bank_mask:0x3
  v_mfma_f32_32x32x16_bf16 v[112:127], a[76:79], v[16:19], v[112:127]
  v_add_f32_dpp v76, v74, v76 row_ror:8 row_mask:0xf bank_mask:0x3
  v_add_f32_dpp v32, v78, v32 row_ror:8 row_mask:0xf bank_mask:0x3
  v_add_f32_dpp v64, v67, v64 row_ror:12 row_mask:0xf bank_mask:0x8
  v_add_f32_dpp v68, v71, v68 row_ror:12 row_mask:0xf bank_mask:0x8
  v_add_f32_dpp v72, v75, v72 row_ror:12 row_mask:0xf bank_mask:0x8
  ds_read_b128 v[16:19], v3 offset:6144
  s_waitcnt lgkmcnt(9)
  v_mfma_f32_32x32x16_bf16 v[80:95], a[8:11], v[20:23], v[80:95]
  v_add_f32_dpp v76, v79, v76 row_ror:12 row_mask:0xf bank_mask:0x8
  v_add_f32_dpp v68, v67, v68 row_ror:12 row_mask:0xf bank_mask:0x7
  v_add_f32_dpp v72, v71, v72 row_ror:12 row_mask:0xf bank_mask:0x7
  v_add_f32_dpp v76, v75, v76 row_ror:12 row_mask:0xf bank_mask:0x7
  v_add_f32_dpp v32, v79, v32 row_ror:12 row_mask:0xf bank_mask:0x7
  s_waitcnt lgkmcnt(7)
  v_mfma_f32_32x32x16_bf16 v[96:111], a[56:59], v[20:23], v[96:111]
  ds_write_b32 v5, v32 offset:272
  ds_read_b64 v[36:37], v6 offset:2048
  v_mfma_f32_32x32x16_bf16 v[112:127], a[72:75], v[20:23], v[112:127]
  ds_read_b32 v61, v60 offset:24
  ds_read_b128 v[20:23], v2 offset:6656
  s_waitcnt lgkmcnt(10)
  v_mfma_f32_32x32x16_bf16 v[80:95], a[4:7], v[24:27], v[80:95]
  s_waitcnt lgkmcnt(8)
  v_mfma_f32_32x32x16_bf16 v[96:111], a[52:55], v[24:27], v[96:111]
  v_mfma_f32_32x32x16_bf16 v[112:127], a[68:71], v[24:27], v[112:127]
  ds_read_b128 v[24:27], v3 offset:7168
  s_waitcnt lgkmcnt(8)
  v_mfma_f32_32x32x16_bf16 v[80:95], a[0:3], v[28:31], v[80:95]
  s_waitcnt lgkmcnt(6)
  v_mfma_f32_32x32x16_bf16 v[96:111], a[48:51], v[28:31], v[96:111]
  v_mfma_f32_32x32x16_bf16 v[112:127], a[64:67], v[28:31], v[112:127]
  ds_read_b128 v[28:31], v2 offset:7680
  s_waitcnt lgkmcnt(6)
  v_mfma_f32_32x32x16_bf16 v[96:111], a[44:47], v[16:19], v[96:111]
  v_mov_b32 v33, 0
  s_nop 4
  v_add_f32_dpp v80, v81, v80 row_ror:4 row_mask:0xf bank_mask:0xe
  v_add_f32_dpp v84, v85, v84 row_ror:4 row_mask:0xf bank_mask:0xe
  v_add_f32_dpp v88, v89, v88 row_ror:4 row_mask:0xf bank_mask:0xe
  v_add_f32_dpp v92, v93, v92 row_ror:4 row_mask:0xf bank_mask:0xe
  v_mfma_f32_32x32x16_bf16 v[112:127], a[60:63], v[16:19], v[112:127]
  v_add_f32_dpp v84, v81, v84 row_ror:4 row_mask:0xf bank_mask:0x1
  v_add_f32_dpp v88, v85, v88 row_ror:4 row_mask:0xf bank_mask:0x1
  v_add_f32_dpp v92, v89, v92 row_ror:4 row_mask:0xf bank_mask:0x1
  v_add_f32_dpp v33, v93, v33 row_ror:4 row_mask:0xf bank_mask:0x1
  v_add_f32_dpp v80, v82, v80 row_ror:8 row_mask:0xf bank_mask:0xc
  s_waitcnt lgkmcnt(3)
  v_cmp_ne_u32 vcc, 0, v61
  s_cbranch_vccnz k1_kernel_gd60
  ds_read_b32 v61, v60 offset:24
  s_mov_b32 s37, 0x40000
  s_branch k1_kernel_sc63
k1_kernel_sp61:
  ds_read_b32 v61, v60 offset:24
k1_kernel_sc63:
  s_waitcnt lgkmcnt(0)
  v_cmp_eq_u32 vcc, 0, v61
  s_cbranch_vccz k1_kernel_sd62
  s_sub_u32 s37, s37, 1
  s_cmp_lg_u32 s37, 0
  s_cbranch_scc1 k1_kernel_sp61
k1_kernel_sd62:
k1_kernel_gd60:
  ds_read_b128 v[16:19], v3 offset:8192
  s_waitcnt lgkmcnt(3)
  v_mfma_f32_32x32x16_bf16 v[96:111], a[40:43], v[20:23], v[96:111]
  v_add_f32_dpp v84, v86, v84 row_ror:8 row_mask:0xf bank_mask:0xc
  v_add_f32_dpp v88, v90, v88 row_ror:8 row_mask:0xf bank_mask:0xc
  v_add_f32_dpp v92, v94, v92 row_ror:8 row_mask:0xf bank_mask:0xc
  v_add_f32_dpp v84, v82, v84 row_ror:8 row_mask:0xf bank_mask:0x3
  v_add_f32_dpp v88, v86, v88 row_ror:8 row_mask:0xf bank_mask:0x3
  v_mfma_f32_32x32x16_bf16 v[112:127], a[56:59], v[20:23], v[112:127]
  v_add_f32_dpp v92, v90, v92 row_ror:8 row_mask:0xf bank_mask:0x3
  v_add_f32_dpp v33, v94, v33 row_ror:8 row_mask:0xf bank_mask:0x3
  v_add_f32_dpp v80, v83, v80 row_ror:12 row_mask:0xf bank_mask:0x8
  v_add_f32_dpp v84, v87, v84 row_ror:12 row_mask:0xf bank_mask:0x8
  v_add_f32_dpp v88, v91, v88 row_ror:12 row_mask:0xf bank_mask:0x8
  ds_read_b128 v[20:23], v2 offset:8704
  s_waitcnt lgkmcnt(3)
  v_mfma_f32_32x32x16_bf16 v[96:111], a[36:39], v[24:27], v[96:111]
  v_add_f32_dpp v92, v95, v92 row_ror:12 row_mask:0xf bank_mask:0x8
  v_add_f32_dpp v84, v83, v84 row_ror:12 row_mask:0xf bank_mask:0x7
  v_add_f32_dpp v88, v87, v88 row_ror:12 row_mask:0xf bank_mask:0x7
  v_add_f32_dpp v92, v91, v92 row_ror:12 row_mask:0xf bank_mask:0x7
  v_add_f32_dpp v33, v95, v33 row_ror:12 row_mask:0xf bank_mask:0x7
  v_mfma_f32_32x32x16_bf16 v[112:127], a[52:55], v[24:27], v[112:127]
  ds_write_b32 v5, v33 offset:528
  ds_read_b64 v[38:39], v6 offset:4096
  ds_read_b128 v[24:27], v3 offset:9216
  s_waitcnt lgkmcnt(5)
  v_mfma_f32_32x32x16_bf16 v[96:111], a[32:35], v[28:31], v[96:111]
  v_mfma_f32_32x32x16_bf16 v[112:127], a[48:51], v[28:31], v[112:127]
  ds_read_b128 v[28:31], v2 offset:9728
  s_waitcnt lgkmcnt(5)
  v_mfma_f32_32x32x16_bf16 v[96:111], a[28:31], v[16:19], v[96:111]
  v_mfma_f32_32x32x16_bf16 v[112:127], a[44:47], v[16:19], v[112:127]
  ds_read_b128 v[16:19], v3 offset:10240
  s_waitcnt lgkmcnt(5)
  v_mfma_f32_32x32x16_bf16 v[96:111], a[24:27], v[20:23], v[96:111]
  v_mfma_f32_32x32x16_bf16 v[112:127], a[40:43], v[20:23], v[112:127]
  ds_read_b32 v61, v60 offset:28
  ds_read_b128 v[20:23], v2 offset:10752
  s_waitcnt lgkmcnt(4)
  v_mfma_f32_32x32x16_bf16 v[96:111], a[20:23], v[24:27], v[96:111]
  v_mfma_f32_32x32x16_bf16 v[112:127], a[36:39], v[24:27], v[112:127]
  ds_read_b128 v[24:27], v3 offset:11264
  s_waitcnt lgkmcnt(4)
  v_mfma_f32_32x32x16_bf16 v[96:111], a[16:19], v[28:31], v[96:111]
  v_mfma_f32_32x32x16_bf16 v[112:127], a[32:35], v[28:31], v[112:127]
  ds_read_b128 v[28:31], v2 offset:11776
  s_waitcnt lgkmcnt(4)
  v_mfma_f32_32x32x16_bf16 v[96:111], a[12:15], v[16:19], v[96:111]
  v_mfma_f32_32x32x16_bf16 v[112:127], a[28:31], v[16:19], v[112:127]
  s_waitcnt lgkmcnt(3)
  v_cmp_ne_u32 vcc, 0, v61
  s_cbranch_vccnz k1_kernel_gd65
  ds_read_b32 v61, v60 offset:28
  s_mov_b32 s37, 0x40000
  s_branch k1_kernel_sc68
k1_kernel_sp66:
  ds_read_b32 v61, v60 offset:28
k1_kernel_sc68:
  s_waitcnt lgkmcnt(0)
  v_cmp_eq_u32 vcc, 0, v61
  s_cbranch_vccz k1_kernel_sd67
  s_sub_u32 s37, s37, 1
  s_cmp_lg_u32 s37, 0
  s_cbranch_scc1 k1_kernel_sp66
k1_kernel_sd67:
k1_kernel_gd65:
  ds_read_b128 v[16:19], v3 offset:12288
  s_waitcnt lgkmcnt(3)
  v_mfma_f32_32x32x16_bf16 v[96:111], a[8:11], v[20:23], v[96:111]
  v_mfma_f32_32x32x16_bf16 v[112:127], a[24:27], v[20:23], v[112:127]
  ds_read_b128 v[20:23], v2 offset:12800
  s_waitcnt lgkmcnt(3)
  v_mfma_f32_32x32x16_bf16 v[96:111], a[4:7], v[24:27], v[96:111]
  v_mfma_f32_32x32x16_bf16 v[112:127], a[20:23], v[24:27], v[112:127]
  ds_read_b128 v[24:27], v3 offset:13312
  s_waitcnt lgkmcnt(3)
  v_mfma_f32_32x32x16_bf16 v[96:111], a[0:3], v[28:31], v[96:111]
  v_mfma_f32_32x32x16_bf16 v[112:127], a[16:19], v[28:31], v[112:127]
  ds_read_b128 v[28:31], v2 offset:13824
  s_waitcnt lgkmcnt(3)
  v_mfma_f32_32x32x16_bf16 v[112:127], a[12:15], v[16:19], v[112:127]
  s_waitcnt lgkmcnt(2)
  v_mfma_f32_32x32x16_bf16 v[112:127], a[8:11], v[20:23], v[112:127]
  v_mov_b32 v34, 0
  s_nop 4
  v_add_f32_dpp v96, v97, v96 row_ror:4 row_mask:0xf bank_mask:0xe
  v_add_f32_dpp v100, v101, v100 row_ror:4 row_mask:0xf bank_mask:0xe
  v_add_f32_dpp v104, v105, v104 row_ror:4 row_mask:0xf bank_mask:0xe
  v_add_f32_dpp v108, v109, v108 row_ror:4 row_mask:0xf bank_mask:0xe
  s_waitcnt lgkmcnt(1)
  v_mfma_f32_32x32x16_bf16 v[112:127], a[4:7], v[24:27], v[112:127]
  v_add_f32_dpp v100, v97, v100 row_ror:4 row_mask:0xf bank_mask:0x1
  v_add_f32_dpp v104, v101, v104 row_ror:4 row_mask:0xf bank_mask:0x1
  v_add_f32_dpp v108, v105, v108 row_ror:4 row_mask:0xf bank_mask:0x1
  v_add_f32_dpp v34, v109, v34 row_ror:4 row_mask:0xf bank_mask:0x1
  v_add_f32_dpp v96, v98, v96 row_ror:8 row_mask:0xf bank_mask:0xc
  s_waitcnt lgkmcnt(0)
  v_mfma_f32_32x32x16_bf16 v[112:127], a[0:3], v[28:31], v[112:127]
  v_add_f32_dpp v100, v102, v100 row_ror:8 row_mask:0xf bank_mask:0xc
  v_add_f32_dpp v104, v106, v104 row_ror:8 row_mask:0xf bank_mask:0xc
  v_add_f32_dpp v108, v110, v108 row_ror:8 row_mask:0xf bank_mask:0xc
  v_add_f32_dpp v100, v98, v100 row_ror:8 row_mask:0xf bank_mask:0x3
  v_add_f32_dpp v104, v102, v104 row_ror:8 row_mask:0xf bank_mask:0x3
  v_add_f32_dpp v108, v106, v108 row_ror:8 row_mask:0xf bank_mask:0x3
  v_add_f32_dpp v34, v110, v34 row_ror:8 row_mask:0xf bank_mask:0x3
  v_add_f32_dpp v96, v99, v96 row_ror:12 row_mask:0xf bank_mask:0x8
  v_add_f32_dpp v100, v103, v100 row_ror:12 row_mask:0xf bank_mask:0x8
  v_add_f32_dpp v104, v107, v104 row_ror:12 row_mask:0xf bank_mask:0x8
  v_add_f32_dpp v108, v111, v108 row_ror:12 row_mask:0xf bank_mask:0x8
  v_add_f32_dpp v100, v99, v100 row_ror:12 row_mask:0xf bank_mask:0x7
  v_add_f32_dpp v104, v103, v104 row_ror:12 row_mask:0xf bank_mask:0x7
  v_add_f32_dpp v108, v107, v108 row_ror:12 row_mask:0xf bank_mask:0x7
  v_add_f32_dpp v34, v111, v34 row_ror:12 row_mask:0xf bank_mask:0x7
  ds_write_b32 v5, v34 offset:1296
  ds_read_b64 v[40:41], v6 offset:10240
  v_mov_b32 v35, 0
  v_add_f32_dpp v112, v113, v112 row_ror:4 row_mask:0xf bank_mask:0xe
  v_add_f32_dpp v116, v117, v116 row_ror:4 row_mask:0xf bank_mask:0xe
  v_add_f32_dpp v120, v121, v120 row_ror:4 row_mask:0xf bank_mask:0xe
  v_add_f32_dpp v124, v125, v124 row_ror:4 row_mask:0xf bank_mask:0xe
  v_add_f32_dpp v116, v113, v116 row_ror:4 row_mask:0xf bank_mask:0x1
  v_add_f32_dpp v120, v117, v120 row_ror:4 row_mask:0xf bank_mask:0x1
  v_add_f32_dpp v124, v121, v124 row_ror:4 row_mask:0xf bank_mask:0x1
  v_add_f32_dpp v35, v125, v35 row_ror:4 row_mask:0xf bank_mask:0x1
  v_add_f32_dpp v112, v114, v112 row_ror:8 row_mask:0xf bank_mask:0xc
  v_add_f32_dpp v116, v118, v116 row_ror:8 row_mask:0xf bank_mask:0xc
  v_add_f32_dpp v120, v122, v120 row_ror:8 row_mask:0xf bank_mask:0xc
  v_add_f32_dpp v124, v126, v124 row_ror:8 row_mask:0xf bank_mask:0xc
  v_add_f32_dpp v116, v114, v116 row_ror:8 row_mask:0xf bank_mask:0x3
  v_add_f32_dpp v120, v118, v120 row_ror:8 row_mask:0xf bank_mask:0x3
  v_add_f32_dpp v124, v122, v124 row_ror:8 row_mask:0xf bank_mask:0x3
  v_add_f32_dpp v35, v126, v35 row_ror:8 row_mask:0xf bank_mask:0x3
  v_add_f32_dpp v112, v115, v112 row_ror:12 row_mask:0xf bank_mask:0x8
  v_add_f32_dpp v116, v119, v116 row_ror:12 row_mask:0xf bank_mask:0x8
  v_add_f32_dpp v120, v123, v120 row_ror:12 row_mask:0xf bank_mask:0x8
  v_add_f32_dpp v124, v127, v124 row_ror:12 row_mask:0xf bank_mask:0x8
  v_add_f32_dpp v116, v115, v116 row_ror:12 row_mask:0xf bank_mask:0x7
  v_add_f32_dpp v120, v119, v120 row_ror:12 row_mask:0xf bank_mask:0x7
  v_add_f32_dpp v124, v123, v124 row_ror:12 row_mask:0xf bank_mask:0x7
  v_add_f32_dpp v35, v127, v35 row_ror:12 row_mask:0xf bank_mask:0x7
  ds_write_b32 v5, v35 offset:1552
  ds_read_b64 v[42:43], v6 offset:12288
  s_waitcnt lgkmcnt(0)
  s_barrier
  ds_read_b32 v32, v5 offset:256
  ds_read_b32 v33, v5 offset:512
  ds_read_b32 v34, v5 offset:1280
  ds_read_b32 v35, v5 offset:1536
  v_lshlrev_b32 v44, 16, v36
  v_and_b32 v45, s24, v36
  v_lshlrev_b32 v46, 16, v37
  v_and_b32 v47, s24, v37
  v_add_f32 v44, v44, v64
  v_add_f32 v45, v45, v68
  v_add_f32 v46, v46, v72
  v_add_f32 v47, v47, v76
  v_cvt_pk_bf16_f32 v37, v46, v47
  v_lshlrev_b32 v48, 16, v38
  v_and_b32 v49, s24, v38
  v_lshlrev_b32 v50, 16, v39
  v_and_b32 v51, s24, v39
  v_add_f32 v48, v48, v80
  v_add_f32 v49, v49, v84
  v_add_f32 v50, v50, v88
  v_add_f32 v51, v51, v92
  v_cvt_pk_bf16_f32 v39, v50, v51
  v_lshlrev_b32 v52, 16, v40
  v_and_b32 v53, s24, v40
  v_lshlrev_b32 v54, 16, v41
  v_and_b32 v55, s24, v41
  v_add_f32 v52, v52, v96
  v_add_f32 v53, v53, v100
  v_add_f32 v54, v54, v104
  v_add_f32 v55, v55, v108
  v_cvt_pk_bf16_f32 v41, v54, v55
  v_lshlrev_b32 v56, 16, v42
  v_and_b32 v57, s24, v42
  v_lshlrev_b32 v58, 16, v43
  v_and_b32 v59, s24, v43
  v_add_f32 v56, v56, v112
  v_add_f32 v57, v57, v116
  v_add_f32 v58, v58, v120
  v_add_f32 v59, v59, v124
  v_cvt_pk_bf16_f32 v43, v58, v59
  s_waitcnt lgkmcnt(3)
  v_add_f32 v44, v44, v32
  v_cvt_pk_bf16_f32 v36, v44, v45
  s_mov_b32 s25, 6553600
  buffer_store_dwordx2 v[36:37], v7, s[8:11], s25 offen sc1
  s_waitcnt lgkmcnt(2)
  v_add_f32 v48, v48, v33
  v_cvt_pk_bf16_f32 v38, v48, v49
  s_mov_b32 s25, 6815744
  buffer_store_dwordx2 v[38:39], v7, s[8:11], s25 offen sc1
  s_waitcnt lgkmcnt(1)
  v_add_f32 v52, v52, v34
  v_cvt_pk_bf16_f32 v40, v52, v53
  s_mov_b32 s25, 7602176
  buffer_store_dwordx2 v[40:41], v7, s[8:11], s25 offen sc1
  s_waitcnt lgkmcnt(0)
  v_add_f32 v56, v56, v35
  v_cvt_pk_bf16_f32 v42, v56, v57
  s_mov_b32 s25, 7864320
  buffer_store_dwordx2 v[42:43], v7, s[8:11], s25 offen sc1
  s_endpgm
k1_end:
  s_endpgm
.globl k3_kernel
.p2align 8
.type k3_kernel,@function
k3_kernel:
  s_cmp_ge_u32 s2, 256
  s_cbranch_scc1 k3_end
  s_load_dwordx2 s[8:9], s[0:1], 104
  s_load_dwordx2 s[48:49], s[0:1], 88
  v_lshrrev_b32 v1, 6, v0
  v_and_b32 v0, 63, v0
  v_readfirstlane_b32 s3, v1
  s_mov_b32 s10, 0x10000000
  s_mov_b32 s11, 0x00020000
  s_bfe_u32 s20, s2, 0x20001
  s_lshl_b32 s20, s20, 2
  s_bfe_u32 s21, s2, 0x20003
  s_add_u32 s20, s20, s21
  s_and_b32 s21, s2, 1
  s_lshl_b32 s21, s21, 3
  s_lshr_b32 s22, s2, 5
  s_add_u32 s21, s21, s22
  s_and_b32 s22, s3, 3
  v_lshlrev_b32 v1, 4, v0
  s_cmp_lt_u32 s3, 4
  s_cbranch_scc1 k3_comp
  s_mov_b32 s14, 3670016
  s_mov_b32 s15, 0x00020000
  s_mov_b32 s18, 131072
  s_mov_b32 s19, 0x00020000
  s_lshl_b32 s23, s20, 17
  s_add_u32 s23, s23, 6291456
  s_mul_i32 s33, s22, 3584
  s_mul_i32 s30, s21, 14336
  s_add_u32 s30, s30, s33
  s_lshl_b32 s31, s22, 11
  s_add_u32 s34, s31, 57344
  s_waitcnt lgkmcnt(0)
  s_add_u32 s12, s8, 8388608
  s_addc_u32 s13, s9, 0
  s_add_u32 s16, s8, s23
  s_addc_u32 s17, s9, 0
  s_lshl_b32 s23, s21, 13
  s_add_u32 s23, s23, s31
  s_add_u32 m0, s34, 0
  s_nop 0
  buffer_load_dwordx4 v1, s[16:19], s31 offen lds
  buffer_load_dwordx4 v1, s[16:19], s31 offen offset:1024 lds
  s_add_u32 s31, s31, 8192
  s_add_u32 m0, s33, 0
  s_nop 0
  buffer_load_dwordx4 v1, s[12:15], s30 offen lds
  buffer_load_dwordx4 v1, s[12:15], s30 offen offset:1024 lds
  buffer_load_dwordx4 v1, s[12:15], s30 offen offset:2048 lds
  s_mov_b32 exec_hi, 0
  buffer_load_dwordx4 v1, s[12:15], s30 offen offset:3072 lds
  s_mov_b32 exec_hi, -1
  s_add_u32 s30, s30, 229376
  s_add_u32 m0, s34, 8192
  s_nop 0
  buffer_load_dwordx4 v1, s[16:19], s31 offen lds
  buffer_load_dwordx4 v1, s[16:19], s31 offen offset:1024 lds
  s_add_u32 s31, s31, 8192
  s_add_u32 m0, s33, 14336
  s_nop 0
  buffer_load_dwordx4 v1, s[12:15], s30 offen lds
  buffer_load_dwordx4 v1, s[12:15], s30 offen offset:1024 lds
  buffer_load_dwordx4 v1, s[12:15], s30 offen offset:2048 lds
  s_mov_b32 exec_hi, 0
  buffer_load_dwordx4 v1, s[12:15], s30 offen offset:3072 lds
  s_mov_b32 exec_hi, -1
  s_add_u32 s30, s30, 229376
  s_add_u32 m0, s34, 16384
  s_nop 0
  buffer_load_dwordx4 v1, s[16:19], s31 offen lds
  buffer_load_dwordx4 v1, s[16:19], s31 offen offset:1024 lds
  s_add_u32 s31, s31, 8192
  s_add_u32 m0, s33, 28672
  s_nop 0
  buffer_load_dwordx4 v1, s[12:15], s30 offen lds
  buffer_load_dwordx4 v1, s[12:15], s30 offen offset:1024 lds
  buffer_load_dwordx4 v1, s[12:15], s30 offen offset:2048 lds
  s_mov_b32 exec_hi, 0
  buffer_load_dwordx4 v1, s[12:15], s30 offen offset:3072 lds
  s_mov_b32 exec_hi, -1
  s_add_u32 s30, s30, 229376
  s_setprio 1
  v_lshrrev_b32 v4, 4, v0
  v_bfe_u32 v5, v0, 2, 2
  v_lshl_add_u32 v6, v4, 3, v5
  v_lshlrev_b32 v6, 8, v6
  v_and_b32 v7, 3, v0
  v_lshl_add_u32 v6, v7, 3, v6
  v_add_u32 v6, 131072, v6
  v_cmp_eq_u32 s[40:41], v4, v5
  v_cmp_eq_u32 s[42:43], 1, v7
  v_cmp_eq_u32 s[44:45], 2, v7
  v_cmp_eq_u32 s[46:47], 3, v7
  v_and_b32 v7, 1, v4
  v_lshl_add_u32 v8, v5, 1, v7
  s_lshl_b32 s24, s22, 1
  v_xor_b32 v8, s24, v8
  v_lshl_add_u32 v2, v8, 5, v6
  v_xor_b32 v3, 32, v2
  v_and_b32 v8, 15, v0
  v_lshl_add_u32 v6, v8, 1, v7
  v_lshlrev_b32 v6, 4, v6
  s_lshl_b32 s24, s22, 9
  s_add_u32 s24, s24, 140288
  v_add_u32 v6, s24, v6
  s_lshl_b32 s24, s20, 2
  s_add_u32 s24, s24, s22
  s_lshl_b32 s58, s24, 12
  s_add_u32 s58, s58, 26214400
  s_lshl_b32 s25, s21, 8
  s_add_u32 s25, s25, s58
  v_lshlrev_b32 v4, 3, v8
  v_add_u32 v4, s25, v4
  s_and_b32 s25, s24, 1
  s_lshl_b32 s25, s25, 6
  s_lshr_b32 s24, s24, 1
  s_mul_i32 s24, s24, 4352
  s_add_u32 s24, s24, s25
  s_add_u32 s24, s24, 25165952
  v_lshlrev_b32 v5, 2, v8
  v_add_u32 v5, s24, v5
  s_lshl_b32 s57, s21, 2
  v_mov_b32 v16, 0x3f803f80
  v_mov_b32 v17, v16
  v_mov_b32 v18, v16
  v_mov_b32 v19, v16
  s_mov_b32 s50, 2097152
  s_mov_b32 s51, 0x00020000
  s_lshr_b32 s60, s21, 3
  s_and_b32 s61, s21, 7
  s_lshl_b32 s59, s20, 1
  s_add_u32 s59, s59, s60
  s_and_b32 s62, s3, 1
  s_lshr_b32 s63, s3, 1
  s_mul_i32 s24, s63, 28
  s_mul_i32 s53, s59, 112
  s_add_u32 s53, s53, s24
  s_lshl_b32 s53, s53, 11
  s_lshl_b32 s25, s62, 12
  s_add_u32 s53, s53, s25
  s_add_u32 s53, s53, 13631488
  s_lshl_b32 s52, s61, 1
  s_add_u32 s52, s52, s62
  s_mul_i32 s52, s52, 112
  s_add_u32 s52, s52, s24
  s_lshl_b32 s52, s52, 10
  s_add_u32 s52, s52, 22020096
  v_lshrrev_b32 v48, 3, v0
  v_bfe_u32 v49, v0, 4, 1
  v_xor_b32 v49, s60, v49
  v_lshlrev_b32 v49, 7, v49
  v_lshl_add_u32 v48, v48, 8, v49
  v_and_b32 v49, 7, v0
  v_lshl_add_u32 v48, v49, 4, v48
  s_lshl_b32 s55, s20, 17
  s_lshl_b32 s25, s61, 14
  s_add_u32 s55, s55, s25
  s_lshl_b32 s25, s22, 12
  s_add_u32 s55, s55, s25
  s_add_u32 s55, s55, 6291456
  s_mov_b32 s4, s52
  s_add_u32 s52, s52, 4096
  s_mov_b32 s5, s52
  s_add_u32 s52, s52, 4096
  s_mov_b32 s6, s52
  s_add_u32 s52, s52, 4096
  s_mov_b32 s7, s52
  s_add_u32 s52, s52, 4096
  s_mov_b32 s28, s52
  s_add_u32 s52, s52, 4096
  s_mov_b32 s29, s52
  s_add_u32 s52, s52, 4096
  s_mov_b32 s32, s52
  s_waitcnt vmcnt(12)
  s_barrier
  s_add_u32 m0, s34, 73728
  s_nop 0
  buffer_load_dwordx4 v1, s[16:19], s23 offen lds
  buffer_load_dwordx4 v1, s[16:19], s23 offen offset:1024 lds
  s_add_u32 m0, s34, 24576
  s_nop 0
  buffer_load_dwordx4 v1, s[16:19], s31 offen lds
  buffer_load_dwordx4 v1, s[16:19], s31 offen offset:1024 lds
  s_add_u32 s31, s31, 8192
  s_add_u32 m0, s33, 43008
  s_nop 0
  buffer_load_dwordx4 v1, s[12:15], s30 offen lds
  buffer_load_dwordx4 v1, s[12:15], s30 offen offset:1024 lds
  buffer_load_dwordx4 v1, s[12:15], s30 offen offset:2048 lds
  s_mov_b32 exec_hi, 0
  buffer_load_dwordx4 v1, s[12:15], s30 offen offset:3072 lds
  s_mov_b32 exec_hi, -1
  s_add_u32 s30, s30, 229376
  s_waitcnt vmcnt(14)
  s_barrier
  s_add_u32 m0, s34, 0
  s_nop 0
  buffer_load_dwordx4 v1, s[16:19], s31 offen lds
  buffer_load_dwordx4 v1, s[16:19], s31 offen offset:1024 lds
  s_add_u32 s31, s31, 8192
  s_add_u32 m0, s33, 0
  s_nop 0
  buffer_load_dwordx4 v1, s[12:15], s30 offen lds
  buffer_load_dwordx4 v1, s[12:15], s30 offen offset:1024 lds
  buffer_load_dwordx4 v1, s[12:15], s30 offen offset:2048 lds
  s_mov_b32 exec_hi, 0
  buffer_load_dwordx4 v1, s[12:15], s30 offen offset:3072 lds
  s_mov_b32 exec_hi, -1
  s_add_u32 s30, s30, 229376
  s_waitcnt vmcnt(14)
  s_barrier
  s_add_u32 m0, s34, 8192
  s_nop 0
  buffer_load_dwordx4 v1, s[16:19], s31 offen lds
  buffer_load_dwordx4 v1, s[16:19], s31 offen offset:1024 lds
  s_add_u32 s31, s31, 8192
  s_add_u32 m0, s33, 14336
  s_nop 0
  buffer_load_dwordx4 v1, s[12:15], s30 offen lds
  buffer_load_dwordx4 v1, s[12:15], s30 offen offset:1024 lds
  buffer_load_dwordx4 v1, s[12:15], s30 offen offset:2048 lds
  s_mov_b32 exec_hi, 0
  buffer_load_dwordx4 v1, s[12:15], s30 offen offset:3072 lds
  s_mov_b32 exec_hi, -1
  s_add_u32 s30, s30, 229376
  s_waitcnt vmcnt(12)
  s_barrier
  ds_read_b64_tr_b16 v[8:9], v2
  ds_read_b64_tr_b16 v[10:11], v2 offset:1024
  ds_read_b64_tr_b16 v[12:13], v3
  ds_read_b64_tr_b16 v[14:15], v3 offset:1024
  s_waitcnt lgkmcnt(2)
  v_mfma_f32_16x16x32_bf16 v[20:23], v[8:11], v[8:11], 0
  v_mfma_f32_16x16x32_bf16 v[28:31], v[16:19], v[8:11], 0
  s_waitcnt lgkmcnt(0)
  v_mfma_f32_16x16x32_bf16 v[24:27], v[12:15], v[12:15], 0
  v_mfma_f32_16x16x32_bf16 v[32:35], v[16:19], v[12:15], 0
  s_nop 3
  v_cndmask_b32 v20, v20, v21, s[42:43]
  v_cndmask_b32 v20, v20, v22, s[44:45]
  v_cndmask_b32 v29, v20, v23, s[46:47]
  v_cndmask_b32 v24, v24, v25, s[42:43]
  v_cndmask_b32 v24, v24, v26, s[44:45]
  v_cndmask_b32 v33, v24, v27, s[46:47]
  s_mov_b64 exec, s[40:41]
  buffer_store_dwordx2 v[28:29], v4, s[8:11], 0 offen sc1
  buffer_store_dwordx2 v[32:33], v4, s[8:11], 0 offen offset:128 sc1
  s_mov_b64 exec, -1
  s_add_u32 m0, s34, 16384
  s_nop 0
  buffer_load_dwordx4 v1, s[16:19], s31 offen lds
  buffer_load_dwordx4 v1, s[16:19], s31 offen offset:1024 lds
  s_add_u32 s31, s31, 8192
  s_add_u32 m0, s33, 28672
  s_nop 0
  buffer_load_dwordx4 v1, s[12:15], s30 offen lds
  buffer_load_dwordx4 v1, s[12:15], s30 offen offset:1024 lds
  buffer_load_dwordx4 v1, s[12:15], s30 offen offset:2048 lds
  s_mov_b32 exec_hi, 0
  buffer_load_dwordx4 v1, s[12:15], s30 offen offset:3072 lds
  s_mov_b32 exec_hi, -1
  s_add_u32 s30, s30, 229376
  s_waitcnt vmcnt(14)
  s_barrier
  s_add_u32 m0, s34, 24576
  s_nop 0
  buffer_load_dwordx4 v1, s[16:19], s31 offen lds
  buffer_load_dwordx4 v1, s[16:19], s31 offen offset:1024 lds
  s_add_u32 s31, s31, 8192
  s_add_u32 m0, s33, 43008
  s_nop 0
  buffer_load_dwordx4 v1, s[12:15], s30 offen lds
  buffer_load_dwordx4 v1, s[12:15], s30 offen offset:1024 lds
  buffer_load_dwordx4 v1, s[12:15], s30 offen offset:2048 lds
  s_mov_b32 exec_hi, 0
  buffer_load_dwordx4 v1, s[12:15], s30 offen offset:3072 lds
  s_mov_b32 exec_hi, -1
  s_add_u32 s30, s30, 229376
  s_waitcnt vmcnt(14)
  s_barrier
  s_add_u32 m0, s34, 0
  s_nop 0
  buffer_load_dwordx4 v1, s[16:19], s31 offen lds
  buffer_load_dwordx4 v1, s[16:19], s31 offen offset:1024 lds
  s_add_u32 s31, s31, 8192
  s_add_u32 m0, s33, 0
  s_nop 0
  buffer_load_dwordx4 v1, s[12:15], s30 offen lds
  buffer_load_dwordx4 v1, s[12:15], s30 offen offset:1024 lds
  buffer_load_dwordx4 v1, s[12:15], s30 offen offset:2048 lds
  s_mov_b32 exec_hi, 0
  buffer_load_dwordx4 v1, s[12:15], s30 offen offset:3072 lds
  s_mov_b32 exec_hi, -1
  s_add_u32 s30, s30, 229376
  s_waitcnt vmcnt(12)
  s_barrier
  s_mov_b64 exec, 1
  buffer_store_dword v16, v5, s[8:11], s57 offen sc1
  s_mov_b64 exec, -1
  s_add_u32 m0, s34, 8192
  s_nop 0
  buffer_load_dwordx4 v1, s[16:19], s31 offen lds
  buffer_load_dwordx4 v1, s[16:19], s31 offen offset:1024 lds
  s_add_u32 s31, s31, 8192
  s_add_u32 m0, s33, 14336
  s_nop 0
  buffer_load_dwordx4 v1, s[12:15], s30 offen lds
  buffer_load_dwordx4 v1, s[12:15], s30 offen offset:1024 lds
  buffer_load_dwordx4 v1, s[12:15], s30 offen offset:2048 lds
  s_mov_b32 exec_hi, 0
  buffer_load_dwordx4 v1, s[12:15], s30 offen offset:3072 lds
  s_mov_b32 exec_hi, -1
  s_add_u32 s30, s30, 229376
  s_waitcnt vmcnt(13)
  s_barrier
  s_add_u32 m0, s34, 16384
  s_nop 0
  buffer_load_dwordx4 v1, s[16:19], s31 offen lds
  buffer_load_dwordx4 v1, s[16:19], s31 offen offset:1024 lds
  s_add_u32 s31, s31, 8192
  s_add_u32 m0, s33, 28672
  s_nop 0
  buffer_load_dwordx4 v1, s[12:15], s30 offen lds
  buffer_load_dwordx4 v1, s[12:15], s30 offen offset:1024 lds
  buffer_load_dwordx4 v1, s[12:15], s30 offen offset:2048 lds
  s_mov_b32 exec_hi, 0
  buffer_load_dwordx4 v1, s[12:15], s30 offen offset:3072 lds
  s_mov_b32 exec_hi, -1
  s_add_u32 s30, s30, 229376
  s_waitcnt vmcnt(13)
  s_barrier
  s_add_u32 m0, s34, 24576
  s_nop 0
  buffer_load_dwordx4 v1, s[16:19], s31 offen lds
  buffer_load_dwordx4 v1, s[16:19], s31 offen offset:1024 lds
  s_add_u32 s31, s31, 8192
  s_add_u32 m0, s33, 43008
  s_nop 0
  buffer_load_dwordx4 v1, s[12:15], s30 offen lds
  buffer_load_dwordx4 v1, s[12:15], s30 offen offset:1024 lds
  buffer_load_dwordx4 v1, s[12:15], s30 offen offset:2048 lds
  s_mov_b32 exec_hi, 0
  buffer_load_dwordx4 v1, s[12:15], s30 offen offset:3072 lds
  s_mov_b32 exec_hi, -1
  s_add_u32 s30, s30, 229376
  s_waitcnt vmcnt(12)
  s_barrier
  buffer_load_dword v8, v5, s[8:11], 0 offen sc1
  s_add_u32 m0, s34, 0
  s_nop 0
  buffer_load_dwordx4 v1, s[16:19], s31 offen lds
  buffer_load_dwordx4 v1, s[16:19], s31 offen offset:1024 lds
  s_add_u32 s31, s31, 8192
  s_add_u32 m0, s33, 0
  s_nop 0
  buffer_load_dwordx4 v1, s[12:15], s30 offen lds
  buffer_load_dwordx4 v1, s[12:15], s30 offen offset:1024 lds
  buffer_load_dwordx4 v1, s[12:15], s30 offen offset:2048 lds
  s_mov_b32 exec_hi, 0
  buffer_load_dwordx4 v1, s[12:15], s30 offen offset:3072 lds
  s_mov_b32 exec_hi, -1
  s_add_u32 s30, s30, 229376
  s_waitcnt vmcnt(13)
  s_barrier
  s_add_u32 m0, s34, 8192
  s_nop 0
  buffer_load_dwordx4 v1, s[16:19], s31 offen lds
  buffer_load_dwordx4 v1, s[16:19], s31 offen offset:1024 lds
  s_add_u32 s31, s31, 8192
  s_add_u32 m0, s33, 14336
  s_nop 0
  buffer_load_dwordx4 v1, s[12:15], s30 offen lds
  buffer_load_dwordx4 v1, s[12:15], s30 offen offset:1024 lds
  buffer_load_dwordx4 v1, s[12:15], s30 offen offset:2048 lds
  s_mov_b32 exec_hi, 0
  buffer_load_dwordx4 v1, s[12:15], s30 offen offset:3072 lds
  s_mov_b32 exec_hi, -1
  s_add_u32 s30, s30, 229376
  s_waitcnt vmcnt(13)
  s_barrier
  s_add_u32 m0, s34, 16384
  s_nop 0
  buffer_load_dwordx4 v1, s[16:19], s31 offen lds
  buffer_load_dwordx4 v1, s[16:19], s31 offen offset:1024 lds
  s_add_u32 s31, s31, 8192
  s_add_u32 m0, s33, 28672
  s_nop 0
  buffer_load_dwordx4 v1, s[12:15], s30 offen lds
  buffer_load_dwordx4 v1, s[12:15], s30 offen offset:1024 lds
  buffer_load_dwordx4 v1, s[12:15], s30 offen offset:2048 lds
  s_mov_b32 exec_hi, 0
  buffer_load_dwordx4 v1, s[12:15], s30 offen offset:3072 lds
  s_mov_b32 exec_hi, -1
  s_add_u32 s30, s30, 229376
  s_waitcnt vmcnt(12)
  s_barrier
  s_mov_b32 s37, 0x40000
  s_branch k3_kernel_pchk3
k3_kernel_poll1:
  buffer_load_dword v8, v5, s[8:11], 0 offen sc1
  s_waitcnt vmcnt(0)
k3_kernel_pchk3:
  v_cmp_eq_u32 vcc, 0, v8
  s_cbranch_vccz k3_kernel_pdone2
  s_sleep 1
  s_sub_u32 s37, s37, 1
  s_cmp_lg_u32 s37, 0
  s_cbranch_scc1 k3_kernel_poll1
k3_kernel_pdone2:
  buffer_load_dwordx4 v[20:23], v1, s[8:11], s58 offen offset:0 sc1
  buffer_load_dwordx4 v[24:27], v1, s[8:11], s58 offen offset:1024 sc1
  buffer_load_dwordx4 v[28:31], v1, s[8:11], s58 offen offset:2048 sc1
  buffer_load_dwordx4 v[32:35], v1, s[8:11], s58 offen offset:3072 sc1
  s_add_u32 m0, s34, 24576
  s_nop 0
  buffer_load_dwordx4 v1, s[16:19], s31 offen lds
  buffer_load_dwordx4 v1, s[16:19], s31 offen offset:1024 lds
  s_add_u32 s31, s31, 8192
  s_add_u32 m0, s33, 43008
  s_nop 0
  buffer_load_dwordx4 v1, s[12:15], s30 offen lds
  buffer_load_dwordx4 v1, s[12:15], s30 offen offset:1024 lds
  buffer_load_dwordx4 v1, s[12:15], s30 offen offset:2048 lds
  s_mov_b32 exec_hi, 0
  buffer_load_dwordx4 v1, s[12:15], s30 offen offset:3072 lds
  s_mov_b32 exec_hi, -1
  s_add_u32 s30, s30, 229376
  s_waitcnt vmcnt(16)
  s_barrier
  buffer_load_dwordx4 v[52:55], v1, s[8:11], s4 offen offset:0
  buffer_load_dwordx4 v[56:59], v1, s[8:11], s4 offen offset:1024
  buffer_load_dwordx4 v[60:63], v1, s[8:11], s4 offen offset:2048
  buffer_load_dwordx4 v[64:67], v1, s[8:11], s4 offen offset:3072
  buffer_load_dwordx4 v[68:71], v1, s[8:11], s5 offen offset:0
  buffer_load_dwordx4 v[72:75], v1, s[8:11], s5 offen offset:1024
  s_waitcnt vmcnt(16)
  s_barrier
  buffer_load_dwordx4 v[76:79], v1, s[8:11], s5 offen offset:2048
  buffer_load_dwordx4 v[80:83], v1, s[8:11], s5 offen offset:3072
  buffer_load_dwordx4 v[84:87], v1, s[8:11], s6 offen offset:0
  buffer_load_dwordx4 v[88:91], v1, s[8:11], s6 offen offset:1024
  buffer_load_dwordx4 v[92:95], v1, s[8:11], s6 offen offset:2048
  buffer_load_dwordx4 v[96:99], v1, s[8:11], s6 offen offset:3072
  s_waitcnt vmcnt(12) lgkmcnt(0)
  s_barrier
  buffer_load_dwordx4 v[100:103], v1, s[8:11], s7 offen offset:0
  buffer_load_dwordx4 v[104:107], v1, s[8:11], s7 offen offset:1024
  buffer_load_dwordx4 v[108:111], v1, s[8:11], s7 offen offset:2048
  buffer_load_dwordx4 v[112:115], v1, s[8:11], s7 offen offset:3072
  buffer_load_dwordx4 v[208:211], v1, s[8:11], s28 offen offset:0
  buffer_load_dwordx4 v[212:215], v1, s[8:11], s28 offen offset:1024
  s_waitcnt vmcnt(24)
  v_pk_add_f32 v[20:21], v[20:21], v[24:25]
  v_pk_add_f32 v[22:23], v[22:23], v[26:27]
  v_pk_add_f32 v[28:29], v[28:29], v[32:33]
  v_pk_add_f32 v[30:31], v[30:31], v[34:35]
  v_pk_add_f32 v[20:21], v[20:21], v[28:29]
  v_pk_add_f32 v[22:23], v[22:23], v[30:31]
  s_nop 1
  v_permlane16_swap_b32 v20, v22
  v_permlane16_swap_b32 v21, v23
  v_pk_add_f32 v[20:21], v[20:21], v[22:23]
  v_mov_b64 v[22:23], v[20:21]
  s_nop 1
  v_permlane32_swap_b32 v20, v22
  v_permlane32_swap_b32 v21, v23
  v_pk_add_f32 v[20:21], v[20:21], v[22:23]
  v_mul_f32 v8, 0x3b000000, v20
  v_mul_f32 v9, 0x3b000000, v21
  v_fma_f32 v9, -v8, v8, v9
  v_max_f32 v9, 0, v9
  v_cvt_pk_bf16_f32 v8, -v8, v9
  v_and_b32 v9, 0xffff0000, v8
  v_lshlrev_b32 v8, 16, v8
  v_add_f32 v9, 0x3727c5ac, v9
  v_cvt_pk_bf16_f32 v9, v9, v9
  v_lshlrev_b32 v9, 16, v9
  v_sqrt_f32 v9, v9
  s_nop 0
  v_cvt_pk_bf16_f32 v9, v9, v9
  v_lshlrev_b32 v9, 16, v9
  v_rcp_f32 v10, v9
  s_nop 0
  v_mul_f32 v10, 0xbfb8aa3b, v10
  ds_write_b128 v6, v[8:11]
  s_waitcnt lgkmcnt(0)
  s_barrier
  s_setprio 0
  s_waitcnt vmcnt(5)
  s_lshl_b32 m0, s22, 11
  s_add_u32 m0, m0, 131072
  s_nop 0
  buffer_load_dwordx4 v48, s[8:11], s55 offen lds
  s_waitcnt vmcnt(5)
  s_add_u32 m0, m0, 1024
  s_add_u32 s55, s55, 2048
  buffer_load_dwordx4 v48, s[8:11], s55 offen lds
  s_waitcnt vmcnt(5)
  buffer_load_dwordx4 v[216:219], v1, s[8:11], s28 offen offset:2048
  s_waitcnt vmcnt(5)
  buffer_load_dwordx4 v[220:223], v1, s[8:11], s28 offen offset:3072
  s_waitcnt vmcnt(5)
  buffer_load_dwordx4 v[224:227], v1, s[8:11], s29 offen offset:0
  s_waitcnt vmcnt(5)
  buffer_load_dwordx4 v[228:231], v1, s[8:11], s29 offen offset:1024
  s_waitcnt vmcnt(5)
  buffer_load_dwordx4 v[232:235], v1, s[8:11], s29 offen offset:2048
  s_waitcnt vmcnt(5)
  buffer_load_dwordx4 v[236:239], v1, s[8:11], s29 offen offset:3072
  s_waitcnt vmcnt(5)
  buffer_load_dwordx4 v[240:243], v1, s[8:11], s32 offen offset:0
  s_waitcnt vmcnt(5)
  buffer_load_dwordx4 v[244:247], v1, s[8:11], s32 offen offset:1024
  s_waitcnt vmcnt(5)
  buffer_load_dwordx4 v[248:251], v1, s[8:11], s32 offen offset:2048
  s_waitcnt vmcnt(5)
  buffer_load_dwordx4 v[252:255], v1, s[8:11], s32 offen offset:3072
  v_lshrrev_b32 v4, 5, v0
  v_and_b32 v5, 31, v0
  v_lshlrev_b32 v2, 4, v5
  v_lshl_add_u32 v2, v4, 10, v2
  s_lshl_b32 s24, s63, 13
  v_add_u32 v2, s24, v2
  v_add_u32 v3, 65536, v2
  s_and_b32 s24, s63, 1
  s_lshl_b32 s24, s24, 4
  v_lshlrev_b32 v6, 3, v4
  v_add_u32 v6, s24, v6
  v_sub_u32 v6, v5, v6
  v_mov_b32 v7, 0x3f80
  v_mov_b32 v12, 0x3f800000
  v_cmp_eq_u32 vcc, 0, v6
  v_cmp_eq_u32 s[26:27], 1, v6
  s_nop 0
  v_cndmask_b32 v8, 0, v7, vcc
  v_cndmask_b32 v8, v8, v12, s[26:27]
  v_cmp_eq_u32 vcc, 2, v6
  v_cmp_eq_u32 s[26:27], 3, v6
  s_nop 0
  v_cndmask_b32 v9, 0, v7, vcc
  v_cndmask_b32 v9, v9, v12, s[26:27]
  v_cmp_eq_u32 vcc, 4, v6
  v_cmp_eq_u32 s[26:27], 5, v6
  s_nop 0
  v_cndmask_b32 v10, 0, v7, vcc
  v_cndmask_b32 v10, v10, v12, s[26:27]
  v_cmp_eq_u32 vcc, 6, v6
  v_cmp_eq_u32 s[26:27], 7, v6
  s_nop 0
  v_cndmask_b32 v11, 0, v7, vcc
  v_cndmask_b32 v11, v11, v12, s[26:27]
  v_bfe_u32 v6, v0, 2, 2
  v_lshl_add_u32 v7, v4, 3, v6
  v_lshlrev_b32 v7, 7, v7
  v_and_b32 v6, 1, v6
  s_lshr_b32 s25, s63, 1
  v_xor_b32 v6, s25, v6
  v_lshl_add_u32 v7, v6, 6, v7
  v_bfe_u32 v6, v0, 4, 1
  v_xor_b32 v6, v6, v4
  v_lshl_add_u32 v7, v6, 5, v7
  v_and_b32 v6, 3, v0
  v_lshl_add_u32 v7, v6, 3, v7
  s_lshl_b32 s24, s24, 7
  s_lshl_b32 s26, s62, 12
  s_add_u32 s24, s24, s26
  s_add_u32 s24, s24, 131072
  v_add_u32 v6, s24, v7
  v_mov_b64 v[176:177], 0
  v_mov_b64 v[178:179], 0
  v_mov_b64 v[180:181], 0
  v_mov_b64 v[182:183], 0
  v_mov_b64 v[184:185], 0
  v_mov_b64 v[186:187], 0
  v_mov_b64 v[188:189], 0
  v_mov_b64 v[190:191], 0
  v_mov_b64 v[192:193], 0
  v_mov_b64 v[194:195], 0
  v_mov_b64 v[196:197], 0
  v_mov_b64 v[198:199], 0
  v_mov_b64 v[200:201], 0
  v_mov_b64 v[202:203], 0
  v_mov_b64 v[204:205], 0
  v_mov_b64 v[206:207], 0
  v_lshrrev_b32 v12, 4, v0
  s_lshl_b32 s24, s3, 2
  v_add_u32 v12, s24, v12
  v_bfe_u32 v13, v0, 3, 1
  v_bfe_u32 v14, v0, 2, 1
  v_and_b32 v15, 3, v0
  v_lshlrev_b32 v4, 8, v12
  v_lshl_add_u32 v4, v13, 7, v4
  v_lshl_add_u32 v4, v15, 5, v4
  v_mul_u32_u24 v14, 8208, v14
  v_add_u32 v4, v4, v14
  v_lshrrev_b32 v14, 4, v12
  v_lshlrev_b32 v5, 5, v14
  v_lshl_add_u32 v5, v13, 4, v5
  v_and_b32 v14, 3, v12
  v_lshl_add_u32 v5, v14, 2, v5
  v_bfe_u32 v14, v12, 2, 2
  v_add_u32 v5, v5, v14
  v_lshlrev_b32 v5, 10, v5
  v_and_b32 v14, 7, v0
  v_lshl_add_u32 v5, v14, 4, v5
  s_lshl_b32 s34, s59, 16
  s_lshl_b32 s24, s61, 7
  s_add_u32 s34, s34, s24
  s_mul_i32 s33, s3, 8208
  s_lshl_b32 s31, s3, 12
  v_and_b32 v49, 31, v0
  v_lshlrev_b32 v49, 7, v49
  s_lshl_b32 s24, s59, 12
  s_add_u32 s24, s24, 25427968
  v_add_u32 v49, s24, v49
  s_barrier
  s_cmp_eq_u32 s3, 4
  s_cbranch_scc0 k3_p2
  s_mov_b32 s37, 0x40000
k3_kernel_poll4:
  buffer_load_dword v50, v49, s[8:11], 0 offen sc1
  s_waitcnt vmcnt(0)
k3_kernel_pchk6:
  v_cmp_eq_u32 vcc, 0, v50
  s_cbranch_vccz k3_kernel_pdone5
  s_sleep 1
  s_sub_u32 s37, s37, 1
  s_cmp_lg_u32 s37, 0
  s_cbranch_scc1 k3_kernel_poll4
k3_kernel_pdone5:
  s_branch k3_p2
k3_comp:
  v_lshlrev_b32 v2, 2, v0
  s_lshl_b32 s26, s3, 8
  s_mul_i32 s27, s21, 896
  s_add_u32 s27, s27, s26
  s_add_u32 s27, s27, 12582912
  s_waitcnt lgkmcnt(0)
  buffer_load_dword v8, v2, s[8:11], s27 offen
  s_add_u32 s27, s27, 14336
  buffer_load_dword v9, v2, s[8:11], s27 offen
  s_add_u32 s27, s27, 14336
  buffer_load_dword v10, v2, s[8:11], s27 offen
  s_add_u32 s27, s27, 14336
  buffer_load_dword v11, v2, s[8:11], s27 offen
  s_add_u32 s27, s27, 14336
  buffer_load_dword v12, v2, s[8:11], s27 offen
  s_add_u32 s27, s27, 14336
  buffer_load_dword v13, v2, s[8:11], s27 offen
  s_add_u32 s27, s27, 14336
  buffer_load_dword v14, v2, s[8:11], s27 offen
  s_add_u32 s27, s27, 14336
  buffer_load_dword v15, v2, s[8:11], s27 offen
  s_add_u32 s27, s27, 14336
  s_add_u32 s26, s26, 139264
  v_add_u32 v7, s26, v2
  s_and_b32 s24, s3, 1
  s_lshr_b32 s25, s3, 1
  s_mul_i32 s26, s25, 7168
  v_add_u32 v2, s26, v1
  v_lshrrev_b32 v16, 4, v0
  v_bfe_u32 v17, v0, 2, 2
  v_lshl_add_u32 v18, v16, 3, v17
  v_lshlrev_b32 v18, 8, v18
  v_and_b32 v19, 3, v0
  v_lshl_add_u32 v18, v19, 3, v18
  v_add_u32 v18, 57344, v18
  v_and_b32 v19, 1, v16
  v_lshl_add_u32 v19, v17, 1, v19
  s_lshl_b32 s26, s24, 2
  v_xor_b32 v19, s26, v19
  v_lshl_add_u32 v3, v19, 5, v18
  v_xor_b32 v4, 32, v3
  v_xor_b32 v5, 64, v3
  v_xor_b32 v6, 0x60, v3
  s_lshl_b32 s38, s20, 1
  s_add_u32 s38, s38, s24
  s_mul_i32 s38, s38, 224
  s_mul_i32 s26, s21, 14
  s_add_u32 s38, s38, s26
  s_mul_i32 s26, s25, 7
  s_add_u32 s38, s38, s26
  s_lshl_b32 s38, s38, 10
  s_add_u32 s38, s38, 13631488
  s_lshl_b32 s39, s20, 1
  s_add_u32 s39, s39, s24
  s_lshl_b32 s39, s39, 12
  s_lshl_b32 s26, s21, 1
  s_add_u32 s26, s26, s25
  s_lshl_b32 s26, s26, 7
  s_add_u32 s39, s39, s26
  s_add_u32 s39, s39, 25427968
  v_lshlrev_b32 v20, 4, v16
  s_mul_i32 s26, s25, 448
  s_add_u32 s26, s26, 139264
  v_add_u32 v20, s26, v20
  v_and_b32 v21, 15, v0
  v_lshlrev_b32 v21, 4, v21
  s_lshl_b32 s26, s24, 10
  s_add_u32 s26, s26, 140288
  v_add_u32 v21, s26, v21
  v_mov_b64 v[96:97], 0
  v_mov_b64 v[98:99], 0
  v_mov_b64 v[100:101], 0
  v_mov_b64 v[102:103], 0
  v_mov_b64 v[104:105], 0
  v_mov_b64 v[106:107], 0
  v_mov_b64 v[108:109], 0
  v_mov_b64 v[110:111], 0
  v_mov_b64 v[112:113], 0
  v_mov_b64 v[114:115], 0
  v_mov_b64 v[116:117], 0
  v_mov_b64 v[118:119], 0
  v_mov_b64 v[120:121], 0
  v_mov_b64 v[122:123], 0
  v_mov_b64 v[124:125], 0
  v_mov_b64 v[126:127], 0
  v_mov_b64 v[128:129], 0
  v_mov_b64 v[130:131], 0
  v_mov_b64 v[132:133], 0
  v_mov_b64 v[134:135], 0
  v_mov_b64 v[136:137], 0
  v_mov_b64 v[138:139], 0
  v_mov_b64 v[140:141], 0
  v_mov_b64 v[142:143], 0
  v_mov_b64 v[144:145], 0
  v_mov_b64 v[146:147], 0
  v_mov_b64 v[148:149], 0
  v_mov_b64 v[150:151], 0
  v_mov_b64 v[152:153], 0
  v_mov_b64 v[154:155], 0
  v_mov_b64 v[156:157], 0
  v_mov_b64 v[158:159], 0
  v_mov_b64 v[160:161], 0
  v_mov_b64 v[162:163], 0
  v_mov_b64 v[164:165], 0
  v_mov_b64 v[166:167], 0
  v_mov_b64 v[168:169], 0
  v_mov_b64 v[170:171], 0
  v_mov_b64 v[172:173], 0
  v_mov_b64 v[174:175], 0
  v_mov_b64 v[176:177], 0
  v_mov_b64 v[178:179], 0
  v_mov_b64 v[180:181], 0
  v_mov_b64 v[182:183], 0
  v_mov_b64 v[184:185], 0
  v_mov_b64 v[186:187], 0
  v_mov_b64 v[188:189], 0
  v_mov_b64 v[190:191], 0
  v_mov_b64 v[192:193], 0
  v_mov_b64 v[194:195], 0
  v_mov_b64 v[196:197], 0
  v_mov_b64 v[198:199], 0
  v_mov_b64 v[200:201], 0
  v_mov_b64 v[202:203], 0
  v_mov_b64 v[204:205], 0
  v_mov_b64 v[206:207], 0
  s_waitcnt vmcnt(0)
  v_pk_add_f32 v[8:9], v[8:9], v[10:11]
  v_pk_add_f32 v[12:13], v[12:13], v[14:15]
  v_pk_add_f32 v[8:9], v[8:9], v[12:13]
  v_add_f32 v8, v8, v9
  ds_write_b32 v7, v8
  v_mov_b32 v0, v20
  v_mov_b32 v7, v21
  s_mov_b32 s50, 2097152
  s_mov_b32 s51, 0x00020000
  s_lshr_b32 s60, s21, 3
  s_and_b32 s61, s21, 7
  s_lshl_b32 s59, s20, 1
  s_add_u32 s59, s59, s60
  s_and_b32 s62, s3, 1
  s_lshr_b32 s63, s3, 1
  s_mul_i32 s24, s63, 28
  s_mul_i32 s53, s59, 112
  s_add_u32 s53, s53, s24
  s_lshl_b32 s53, s53, 11
  s_lshl_b32 s25, s62, 12
  s_add_u32 s53, s53, s25
  s_add_u32 s53, s53, 13631488
  s_lshl_b32 s52, s61, 1
  s_add_u32 s52, s52, s62
  s_mul_i32 s52, s52, 112
  s_add_u32 s52, s52, s24
  s_lshl_b32 s52, s52, 10
  s_add_u32 s52, s52, 22020096
  s_lshl_b32 s55, s20, 17
  s_lshl_b32 s25, s61, 14
  s_add_u32 s55, s55, s25
  s_lshl_b32 s25, s22, 12
  s_add_u32 s55, s55, s25
  s_add_u32 s55, s55, 6291456
  s_mov_b32 s4, s52
  s_add_u32 s52, s52, 4096
  s_mov_b32 s5, s52
  s_add_u32 s52, s52, 4096
  s_mov_b32 s6, s52
  s_add_u32 s52, s52, 4096
  s_mov_b32 s7, s52
  s_add_u32 s52, s52, 4096
  s_mov_b32 s28, s52
  s_add_u32 s52, s52, 4096
  s_mov_b32 s29, s52
  s_add_u32 s52, s52, 4096
  s_mov_b32 s32, s52
  s_barrier
  ds_read_b64_tr_b16 v[8:9], v3 offset:0
  ds_read_b64_tr_b16 v[10:11], v3 offset:1024
  ds_read_b64_tr_b16 v[12:13], v4 offset:0
  ds_read_b64_tr_b16 v[14:15], v4 offset:1024
  ds_read_b64_tr_b16 v[16:17], v5 offset:0
  ds_read_b64_tr_b16 v[18:19], v5 offset:1024
  ds_read_b64_tr_b16 v[20:21], v6 offset:0
  ds_read_b64_tr_b16 v[22:23], v6 offset:1024
  ds_read_b128 v[24:27], v2 offset:0
  ds_read_b128 v[28:31], v2 offset:1024
  ds_read_b128 v[32:35], v2 offset:2048
  ds_read_b128 v[36:39], v2 offset:3072
  ds_read_b128 v[40:43], v2 offset:4096
  ds_read_b128 v[44:47], v2 offset:5120
  ds_read_b128 v[48:51], v2 offset:6144
  s_mov_b32 s36, 3
k3_kernel_loop7:
  s_waitcnt lgkmcnt(0)
  v_mfma_f32_16x16x32_bf16 v[96:99], v[24:27], v[8:11], v[96:99]
  s_barrier
  ds_read_b64_tr_b16 v[52:53], v3 offset:8192
  v_mfma_f32_16x16x32_bf16 v[100:103], v[24:27], v[12:15], v[100:103]
  ds_read_b64_tr_b16 v[54:55], v3 offset:9216
  v_mfma_f32_16x16x32_bf16 v[104:107], v[24:27], v[16:19], v[104:107]
  ds_read_b64_tr_b16 v[56:57], v4 offset:8192
  v_mfma_f32_16x16x32_bf16 v[108:111], v[24:27], v[20:23], v[108:111]
  ds_read_b64_tr_b16 v[58:59], v4 offset:9216
  v_mfma_f32_16x16x32_bf16 v[112:115], v[28:31], v[8:11], v[112:115]
  ds_read_b64_tr_b16 v[60:61], v5 offset:8192
  v_mfma_f32_16x16x32_bf16 v[116:119], v[28:31], v[12:15], v[116:119]
  ds_read_b64_tr_b16 v[62:63], v5 offset:9216
  v_mfma_f32_16x16x32_bf16 v[120:123], v[28:31], v[16:19], v[120:123]
  ds_read_b64_tr_b16 v[64:65], v6 offset:8192
  v_mfma_f32_16x16x32_bf16 v[124:127], v[28:31], v[20:23], v[124:127]
  ds_read_b64_tr_b16 v[66:67], v6 offset:9216
  v_mfma_f32_16x16x32_bf16 v[128:131], v[32:35], v[8:11], v[128:131]
  ds_read_b128 v[68:71], v2 offset:14336
  v_mfma_f32_16x16x32_bf16 v[132:135], v[32:35], v[12:15], v[132:135]
  ds_read_b128 v[72:75], v2 offset:15360
  v_mfma_f32_16x16x32_bf16 v[136:139], v[32:35], v[16:19], v[136:139]
  ds_read_b128 v[76:79], v2 offset:16384
  v_mfma_f32_16x16x32_bf16 v[140:143], v[32:35], v[20:23], v[140:143]
  ds_read_b128 v[80:83], v2 offset:17408
  v_mfma_f32_16x16x32_bf16 v[144:147], v[36:39], v[8:11], v[144:147]
  ds_read_b128 v[84:87], v2 offset:18432
  v_mfma_f32_16x16x32_bf16 v[148:151], v[36:39], v[12:15], v[148:151]
  ds_read_b128 v[88:91], v2 offset:19456
  v_mfma_f32_16x16x32_bf16 v[152:155], v[36:39], v[16:19], v[152:155]
  ds_read_b128 v[92:95], v2 offset:20480
  v_mfma_f32_16x16x32_bf16 v[156:159], v[36:39], v[20:23], v[156:159]
  v_mfma_f32_16x16x32_bf16 v[160:163], v[40:43], v[8:11], v[160:163]
  v_mfma_f32_16x16x32_bf16 v[164:167], v[40:43], v[12:15], v[164:167]
  v_mfma_f32_16x16x32_bf16 v[168:171], v[40:43], v[16:19], v[168:171]
  v_mfma_f32_16x16x32_bf16 v[172:175], v[40:43], v[20:23], v[172:175]
  v_mfma_f32_16x16x32_bf16 v[176:179], v[44:47], v[8:11], v[176:179]
  v_mfma_f32_16x16x32_bf16 v[180:183], v[44:47], v[12:15], v[180:183]
  v_mfma_f32_16x16x32_bf16 v[184:187], v[44:47], v[16:19], v[184:187]
  v_mfma_f32_16x16x32_bf16 v[188:191], v[44:47], v[20:23], v[188:191]
  v_mfma_f32_16x16x32_bf16 v[192:195], v[48:51], v[8:11], v[192:195]
  v_mfma_f32_16x16x32_bf16 v[196:199], v[48:51], v[12:15], v[196:199]
  v_mfma_f32_16x16x32_bf16 v[200:203], v[48:51], v[16:19], v[200:203]
  v_mfma_f32_16x16x32_bf16 v[204:207], v[48:51], v[20:23], v[204:207]
  s_waitcnt lgkmcnt(0)
  v_mfma_f32_16x16x32_bf16 v[96:99], v[68:71], v[52:55], v[96:99]
  s_barrier
  ds_read_b64_tr_b16 v[8:9], v3 offset:16384
  v_mfma_f32_16x16x32_bf16 v[100:103], v[68:71], v[56:59], v[100:103]
  ds_read_b64_tr_b16 v[10:11], v3 offset:17408
  v_mfma_f32_16x16x32_bf16 v[104:107], v[68:71], v[60:63], v[104:107]
  ds_read_b64_tr_b16 v[12:13], v4 offset:16384
  v_mfma_f32_16x16x32_bf16 v[108:111], v[68:71], v[64:67], v[108:111]
  ds_read_b64_tr_b16 v[14:15], v4 offset:17408
  v_mfma_f32_16x16x32_bf16 v[112:115], v[72:75], v[52:55], v[112:115]
  ds_read_b64_tr_b16 v[16:17], v5 offset:16384
  v_mfma_f32_16x16x32_bf16 v[116:119], v[72:75], v[56:59], v[116:119]
  ds_read_b64_tr_b16 v[18:19], v5 offset:17408
  v_mfma_f32_16x16x32_bf16 v[120:123], v[72:75], v[60:63], v[120:123]
  ds_read_b64_tr_b16 v[20:21], v6 offset:16384
  v_mfma_f32_16x16x32_bf16 v[124:127], v[72:75], v[64:67], v[124:127]
  ds_read_b64_tr_b16 v[22:23], v6 offset:17408
  v_mfma_f32_16x16x32_bf16 v[128:131], v[76:79], v[52:55], v[128:131]
  ds_read_b128 v[24:27], v2 offset:28672
  v_mfma_f32_16x16x32_bf16 v[132:135], v[76:79], v[56:59], v[132:135]
  ds_read_b128 v[28:31], v2 offset:29696
  v_mfma_f32_16x16x32_bf16 v[136:139], v[76:79], v[60:63], v[136:139]
  ds_read_b128 v[32:35], v2 offset:30720
  v_mfma_f32_16x16x32_bf16 v[140:143], v[76:79], v[64:67], v[140:143]
  ds_read_b128 v[36:39], v2 offset:31744
  v_mfma_f32_16x16x32_bf16 v[144:147], v[80:83], v[52:55], v[144:147]
  ds_read_b128 v[40:43], v2 offset:32768
  v_mfma_f32_16x16x32_bf16 v[148:151], v[80:83], v[56:59], v[148:151]
  ds_read_b128 v[44:47], v2 offset:33792
  v_mfma_f32_16x16x32_bf16 v[152:155], v[80:83], v[60:63], v[152:155]
  ds_read_b128 v[48:51], v2 offset:34816
  v_mfma_f32_16x16x32_bf16 v[156:159], v[80:83], v[64:67], v[156:159]
  v_mfma_f32_16x16x32_bf16 v[160:163], v[84:87], v[52:55], v[160:163]
  v_mfma_f32_16x16x32_bf16 v[164:167], v[84:87], v[56:59], v[164:167]
  v_mfma_f32_16x16x32_bf16 v[168:171], v[84:87], v[60:63], v[168:171]
  v_mfma_f32_16x16x32_bf16 v[172:175], v[84:87], v[64:67], v[172:175]
  v_mfma_f32_16x16x32_bf16 v[176:179], v[88:91], v[52:55], v[176:179]
  v_mfma_f32_16x16x32_bf16 v[180:183], v[88:91], v[56:59], v[180:183]
  v_mfma_f32_16x16x32_bf16 v[184:187], v[88:91], v[60:63], v[184:187]
  v_mfma_f32_16x16x32_bf16 v[188:191], v[88:91], v[64:67], v[188:191]
  v_mfma_f32_16x16x32_bf16 v[192:195], v[92:95], v[52:55], v[192:195]
  v_mfma_f32_16x16x32_bf16 v[196:199], v[92:95], v[56:59], v[196:199]
  v_mfma_f32_16x16x32_bf16 v[200:203], v[92:95], v[60:63], v[200:203]
  v_mfma_f32_16x16x32_bf16 v[204:207], v[92:95], v[64:67], v[204:207]
  s_waitcnt lgkmcnt(0)
  v_mfma_f32_16x16x32_bf16 v[96:99], v[24:27], v[8:11], v[96:99]
  s_barrier
  ds_read_b64_tr_b16 v[52:53], v3 offset:24576
  v_mfma_f32_16x16x32_bf16 v[100:103], v[24:27], v[12:15], v[100:103]
  ds_read_b64_tr_b16 v[54:55], v3 offset:25600
  v_mfma_f32_16x16x32_bf16 v[104:107], v[24:27], v[16:19], v[104:107]
  ds_read_b64_tr_b16 v[56:57], v4 offset:24576
  v_mfma_f32_16x16x32_bf16 v[108:111], v[24:27], v[20:23], v[108:111]
  ds_read_b64_tr_b16 v[58:59], v4 offset:25600
  v_mfma_f32_16x16x32_bf16 v[112:115], v[28:31], v[8:11], v[112:115]
  ds_read_b64_tr_b16 v[60:61], v5 offset:24576
  v_mfma_f32_16x16x32_bf16 v[116:119], v[28:31], v[12:15], v[116:119]
  ds_read_b64_tr_b16 v[62:63], v5 offset:25600
  v_mfma_f32_16x16x32_bf16 v[120:123], v[28:31], v[16:19], v[120:123]
  ds_read_b64_tr_b16 v[64:65], v6 offset:24576
  v_mfma_f32_16x16x32_bf16 v[124:127], v[28:31], v[20:23], v[124:127]
  ds_read_b64_tr_b16 v[66:67], v6 offset:25600
  v_mfma_f32_16x16x32_bf16 v[128:131], v[32:35], v[8:11], v[128:131]
  ds_read_b128 v[68:71], v2 offset:43008
  v_mfma_f32_16x16x32_bf16 v[132:135], v[32:35], v[12:15], v[132:135]
  ds_read_b128 v[72:75], v2 offset:44032
  v_mfma_f32_16x16x32_bf16 v[136:139], v[32:35], v[16:19], v[136:139]
  ds_read_b128 v[76:79], v2 offset:45056
  v_mfma_f32_16x16x32_bf16 v[140:143], v[32:35], v[20:23], v[140:143]
  ds_read_b128 v[80:83], v2 offset:46080
  v_mfma_f32_16x16x32_bf16 v[144:147], v[36:39], v[8:11], v[144:147]
  ds_read_b128 v[84:87], v2 offset:47104
  v_mfma_f32_16x16x32_bf16 v[148:151], v[36:39], v[12:15], v[148:151]
  ds_read_b128 v[88:91], v2 offset:48128
  v_mfma_f32_16x16x32_bf16 v[152:155], v[36:39], v[16:19], v[152:155]
  ds_read_b128 v[92:95], v2 offset:49152
  v_mfma_f32_16x16x32_bf16 v[156:159], v[36:39], v[20:23], v[156:159]
  v_mfma_f32_16x16x32_bf16 v[160:163], v[40:43], v[8:11], v[160:163]
  v_mfma_f32_16x16x32_bf16 v[164:167], v[40:43], v[12:15], v[164:167]
  v_mfma_f32_16x16x32_bf16 v[168:171], v[40:43], v[16:19], v[168:171]
  v_mfma_f32_16x16x32_bf16 v[172:175], v[40:43], v[20:23], v[172:175]
  v_mfma_f32_16x16x32_bf16 v[176:179], v[44:47], v[8:11], v[176:179]
  v_mfma_f32_16x16x32_bf16 v[180:183], v[44:47], v[12:15], v[180:183]
  v_mfma_f32_16x16x32_bf16 v[184:187], v[44:47], v[16:19], v[184:187]
  v_mfma_f32_16x16x32_bf16 v[188:191], v[44:47], v[20:23], v[188:191]
  v_mfma_f32_16x16x32_bf16 v[192:195], v[48:51], v[8:11], v[192:195]
  v_mfma_f32_16x16x32_bf16 v[196:199], v[48:51], v[12:15], v[196:199]
  v_mfma_f32_16x16x32_bf16 v[200:203], v[48:51], v[16:19], v[200:203]
  v_mfma_f32_16x16x32_bf16 v[204:207], v[48:51], v[20:23], v[204:207]
  s_waitcnt lgkmcnt(0)
  v_mfma_f32_16x16x32_bf16 v[96:99], v[68:71], v[52:55], v[96:99]
  s_barrier
  ds_read_b64_tr_b16 v[8:9], v3 offset:0
  v_mfma_f32_16x16x32_bf16 v[100:103], v[68:71], v[56:59], v[100:103]
  ds_read_b64_tr_b16 v[10:11], v3 offset:1024
  v_mfma_f32_16x16x32_bf16 v[104:107], v[68:71], v[60:63], v[104:107]
  ds_read_b64_tr_b16 v[12:13], v4 offset:0
  v_mfma_f32_16x16x32_bf16 v[108:111], v[68:71], v[64:67], v[108:111]
  ds_read_b64_tr_b16 v[14:15], v4 offset:1024
  v_mfma_f32_16x16x32_bf16 v[112:115], v[72:75], v[52:55], v[112:115]
  ds_read_b64_tr_b16 v[16:17], v5 offset:0
  v_mfma_f32_16x16x32_bf16 v[116:119], v[72:75], v[56:59], v[116:119]
  ds_read_b64_tr_b16 v[18:19], v5 offset:1024
  v_mfma_f32_16x16x32_bf16 v[120:123], v[72:75], v[60:63], v[120:123]
  ds_read_b64_tr_b16 v[20:21], v6 offset:0
  v_mfma_f32_16x16x32_bf16 v[124:127], v[72:75], v[64:67], v[124:127]
  ds_read_b64_tr_b16 v[22:23], v6 offset:1024
  v_mfma_f32_16x16x32_bf16 v[128:131], v[76:79], v[52:55], v[128:131]
  ds_read_b128 v[24:27], v2 offset:0
  v_mfma_f32_16x16x32_bf16 v[132:135], v[76:79], v[56:59], v[132:135]
  ds_read_b128 v[28:31], v2 offset:1024
  v_mfma_f32_16x16x32_bf16 v[136:139], v[76:79], v[60:63], v[136:139]
  ds_read_b128 v[32:35], v2 offset:2048
  v_mfma_f32_16x16x32_bf16 v[140:143], v[76:79], v[64:67], v[140:143]
  ds_read_b128 v[36:39], v2 offset:3072
  v_mfma_f32_16x16x32_bf16 v[144:147], v[80:83], v[52:55], v[144:147]
  ds_read_b128 v[40:43], v2 offset:4096
  v_mfma_f32_16x16x32_bf16 v[148:151], v[80:83], v[56:59], v[148:151]
  ds_read_b128 v[44:47], v2 offset:5120
  v_mfma_f32_16x16x32_bf16 v[152:155], v[80:83], v[60:63], v[152:155]
  ds_read_b128 v[48:51], v2 offset:6144
  v_mfma_f32_16x16x32_bf16 v[156:159], v[80:83], v[64:67], v[156:159]
  v_mfma_f32_16x16x32_bf16 v[160:163], v[84:87], v[52:55], v[160:163]
  v_mfma_f32_16x16x32_bf16 v[164:167], v[84:87], v[56:59], v[164:167]
  v_mfma_f32_16x16x32_bf16 v[168:171], v[84:87], v[60:63], v[168:171]
  v_mfma_f32_16x16x32_bf16 v[172:175], v[84:87], v[64:67], v[172:175]
  v_mfma_f32_16x16x32_bf16 v[176:179], v[88:91], v[52:55], v[176:179]
  v_mfma_f32_16x16x32_bf16 v[180:183], v[88:91], v[56:59], v[180:183]
  v_mfma_f32_16x16x32_bf16 v[184:187], v[88:91], v[60:63], v[184:187]
  v_mfma_f32_16x16x32_bf16 v[188:191], v[88:91], v[64:67], v[188:191]
  v_mfma_f32_16x16x32_bf16 v[192:195], v[92:95], v[52:55], v[192:195]
  v_mfma_f32_16x16x32_bf16 v[196:199], v[92:95], v[56:59], v[196:199]
  v_mfma_f32_16x16x32_bf16 v[200:203], v[92:95], v[60:63], v[200:203]
  v_mfma_f32_16x16x32_bf16 v[204:207], v[92:95], v[64:67], v[204:207]
  s_sub_u32 s36, s36, 1
  s_cmp_lg_u32 s36, 0
  s_cbranch_scc1 k3_kernel_loop7
  s_waitcnt lgkmcnt(0)
  v_mfma_f32_16x16x32_bf16 v[96:99], v[24:27], v[8:11], v[96:99]
  s_barrier
  ds_read_b64_tr_b16 v[52:53], v3 offset:8192
  v_mfma_f32_16x16x32_bf16 v[100:103], v[24:27], v[12:15], v[100:103]
  ds_read_b64_tr_b16 v[54:55], v3 offset:9216
  v_mfma_f32_16x16x32_bf16 v[104:107], v[24:27], v[16:19], v[104:107]
  ds_read_b64_tr_b16 v[56:57], v4 offset:8192
  v_mfma_f32_16x16x32_bf16 v[108:111], v[24:27], v[20:23], v[108:111]
  ds_read_b64_tr_b16 v[58:59], v4 offset:9216
  v_mfma_f32_16x16x32_bf16 v[112:115], v[28:31], v[8:11], v[112:115]
  ds_read_b64_tr_b16 v[60:61], v5 offset:8192
  v_mfma_f32_16x16x32_bf16 v[116:119], v[28:31], v[12:15], v[116:119]
  ds_read_b64_tr_b16 v[62:63], v5 offset:9216
  v_mfma_f32_16x16x32_bf16 v[120:123], v[28:31], v[16:19], v[120:123]
  ds_read_b64_tr_b16 v[64:65], v6 offset:8192
  v_mfma_f32_16x16x32_bf16 v[124:127], v[28:31], v[20:23], v[124:127]
  ds_read_b64_tr_b16 v[66:67], v6 offset:9216
  v_mfma_f32_16x16x32_bf16 v[128:131], v[32:35], v[8:11], v[128:131]
  ds_read_b128 v[68:71], v2 offset:14336
  v_mfma_f32_16x16x32_bf16 v[132:135], v[32:35], v[12:15], v[132:135]
  ds_read_b128 v[72:75], v2 offset:15360
  v_mfma_f32_16x16x32_bf16 v[136:139], v[32:35], v[16:19], v[136:139]
  ds_read_b128 v[76:79], v2 offset:16384
  v_mfma_f32_16x16x32_bf16 v[140:143], v[32:35], v[20:23], v[140:143]
  ds_read_b128 v[80:83], v2 offset:17408
  v_mfma_f32_16x16x32_bf16 v[144:147], v[36:39], v[8:11], v[144:147]
  ds_read_b128 v[84:87], v2 offset:18432
  v_mfma_f32_16x16x32_bf16 v[148:151], v[36:39], v[12:15], v[148:151]
  ds_read_b128 v[88:91], v2 offset:19456
  v_mfma_f32_16x16x32_bf16 v[152:155], v[36:39], v[16:19], v[152:155]
  ds_read_b128 v[92:95], v2 offset:20480
  v_mfma_f32_16x16x32_bf16 v[156:159], v[36:39], v[20:23], v[156:159]
  v_mfma_f32_16x16x32_bf16 v[160:163], v[40:43], v[8:11], v[160:163]
  v_mfma_f32_16x16x32_bf16 v[164:167], v[40:43], v[12:15], v[164:167]
  v_mfma_f32_16x16x32_bf16 v[168:171], v[40:43], v[16:19], v[168:171]
  v_mfma_f32_16x16x32_bf16 v[172:175], v[40:43], v[20:23], v[172:175]
  v_mfma_f32_16x16x32_bf16 v[176:179], v[44:47], v[8:11], v[176:179]
  v_mfma_f32_16x16x32_bf16 v[180:183], v[44:47], v[12:15], v[180:183]
  v_mfma_f32_16x16x32_bf16 v[184:187], v[44:47], v[16:19], v[184:187]
  v_mfma_f32_16x16x32_bf16 v[188:191], v[44:47], v[20:23], v[188:191]
  v_mfma_f32_16x16x32_bf16 v[192:195], v[48:51], v[8:11], v[192:195]
  v_mfma_f32_16x16x32_bf16 v[196:199], v[48:51], v[12:15], v[196:199]
  v_mfma_f32_16x16x32_bf16 v[200:203], v[48:51], v[16:19], v[200:203]
  v_mfma_f32_16x16x32_bf16 v[204:207], v[48:51], v[20:23], v[204:207]
  s_waitcnt lgkmcnt(0)
  v_mfma_f32_16x16x32_bf16 v[96:99], v[68:71], v[52:55], v[96:99]
  s_barrier
  ds_read_b64_tr_b16 v[8:9], v3 offset:16384
  v_mfma_f32_16x16x32_bf16 v[100:103], v[68:71], v[56:59], v[100:103]
  ds_read_b64_tr_b16 v[10:11], v3 offset:17408
  v_mfma_f32_16x16x32_bf16 v[104:107], v[68:71], v[60:63], v[104:107]
  ds_read_b64_tr_b16 v[12:13], v4 offset:16384
  v_mfma_f32_16x16x32_bf16 v[108:111], v[68:71], v[64:67], v[108:111]
  ds_read_b64_tr_b16 v[14:15], v4 offset:17408
  v_mfma_f32_16x16x32_bf16 v[112:115], v[72:75], v[52:55], v[112:115]
  ds_read_b64_tr_b16 v[16:17], v5 offset:16384
  v_mfma_f32_16x16x32_bf16 v[116:119], v[72:75], v[56:59], v[116:119]
  ds_read_b64_tr_b16 v[18:19], v5 offset:17408
  v_mfma_f32_16x16x32_bf16 v[120:123], v[72:75], v[60:63], v[120:123]
  ds_read_b64_tr_b16 v[20:21], v6 offset:16384
  v_mfma_f32_16x16x32_bf16 v[124:127], v[72:75], v[64:67], v[124:127]
  ds_read_b64_tr_b16 v[22:23], v6 offset:17408
  v_mfma_f32_16x16x32_bf16 v[128:131], v[76:79], v[52:55], v[128:131]
  ds_read_b128 v[24:27], v2 offset:28672
  v_mfma_f32_16x16x32_bf16 v[132:135], v[76:79], v[56:59], v[132:135]
  ds_read_b128 v[28:31], v2 offset:29696
  v_mfma_f32_16x16x32_bf16 v[136:139], v[76:79], v[60:63], v[136:139]
  ds_read_b128 v[32:35], v2 offset:30720
  v_mfma_f32_16x16x32_bf16 v[140:143], v[76:79], v[64:67], v[140:143]
  ds_read_b128 v[36:39], v2 offset:31744
  v_mfma_f32_16x16x32_bf16 v[144:147], v[80:83], v[52:55], v[144:147]
  ds_read_b128 v[40:43], v2 offset:32768
  v_mfma_f32_16x16x32_bf16 v[148:151], v[80:83], v[56:59], v[148:151]
  ds_read_b128 v[44:47], v2 offset:33792
  v_mfma_f32_16x16x32_bf16 v[152:155], v[80:83], v[60:63], v[152:155]
  ds_read_b128 v[48:51], v2 offset:34816
  v_mfma_f32_16x16x32_bf16 v[156:159], v[80:83], v[64:67], v[156:159]
  v_mfma_f32_16x16x32_bf16 v[160:163], v[84:87], v[52:55], v[160:163]
  v_mfma_f32_16x16x32_bf16 v[164:167], v[84:87], v[56:59], v[164:167]
  v_mfma_f32_16x16x32_bf16 v[168:171], v[84:87], v[60:63], v[168:171]
  v_mfma_f32_16x16x32_bf16 v[172:175], v[84:87], v[64:67], v[172:175]
  v_mfma_f32_16x16x32_bf16 v[176:179], v[88:91], v[52:55], v[176:179]
  v_mfma_f32_16x16x32_bf16 v[180:183], v[88:91], v[56:59], v[180:183]
  v_mfma_f32_16x16x32_bf16 v[184:187], v[88:91], v[60:63], v[184:187]
  v_mfma_f32_16x16x32_bf16 v[188:191], v[88:91], v[64:67], v[188:191]
  v_mfma_f32_16x16x32_bf16 v[192:195], v[92:95], v[52:55], v[192:195]
  v_mfma_f32_16x16x32_bf16 v[196:199], v[92:95], v[56:59], v[196:199]
  v_mfma_f32_16x16x32_bf16 v[200:203], v[92:95], v[60:63], v[200:203]
  v_mfma_f32_16x16x32_bf16 v[204:207], v[92:95], v[64:67], v[204:207]
  s_waitcnt lgkmcnt(0)
  v_mfma_f32_16x16x32_bf16 v[96:99], v[24:27], v[8:11], v[96:99]
  s_barrier
  ds_read_b64_tr_b16 v[52:53], v3 offset:24576
  v_mfma_f32_16x16x32_bf16 v[100:103], v[24:27], v[12:15], v[100:103]
  ds_read_b64_tr_b16 v[54:55], v3 offset:25600
  v_mfma_f32_16x16x32_bf16 v[104:107], v[24:27], v[16:19], v[104:107]
  ds_read_b64_tr_b16 v[56:57], v4 offset:24576
  v_mfma_f32_16x16x32_bf16 v[108:111], v[24:27], v[20:23], v[108:111]
  ds_read_b64_tr_b16 v[58:59], v4 offset:25600
  v_mfma_f32_16x16x32_bf16 v[112:115], v[28:31], v[8:11], v[112:115]
  ds_read_b64_tr_b16 v[60:61], v5 offset:24576
  v_mfma_f32_16x16x32_bf16 v[116:119], v[28:31], v[12:15], v[116:119]
  ds_read_b64_tr_b16 v[62:63], v5 offset:25600
  v_mfma_f32_16x16x32_bf16 v[120:123], v[28:31], v[16:19], v[120:123]
  ds_read_b64_tr_b16 v[64:65], v6 offset:24576
  v_mfma_f32_16x16x32_bf16 v[124:127], v[28:31], v[20:23], v[124:127]
  ds_read_b64_tr_b16 v[66:67], v6 offset:25600
  v_mfma_f32_16x16x32_bf16 v[128:131], v[32:35], v[8:11], v[128:131]
  ds_read_b128 v[68:71], v2 offset:43008
  v_mfma_f32_16x16x32_bf16 v[132:135], v[32:35], v[12:15], v[132:135]
  ds_read_b128 v[72:75], v2 offset:44032
  v_mfma_f32_16x16x32_bf16 v[136:139], v[32:35], v[16:19], v[136:139]
  ds_read_b128 v[76:79], v2 offset:45056
  v_mfma_f32_16x16x32_bf16 v[140:143], v[32:35], v[20:23], v[140:143]
  ds_read_b128 v[80:83], v2 offset:46080
  v_mfma_f32_16x16x32_bf16 v[144:147], v[36:39], v[8:11], v[144:147]
  ds_read_b128 v[84:87], v2 offset:47104
  v_mfma_f32_16x16x32_bf16 v[148:151], v[36:39], v[12:15], v[148:151]
  ds_read_b128 v[88:91], v2 offset:48128
  v_mfma_f32_16x16x32_bf16 v[152:155], v[36:39], v[16:19], v[152:155]
  ds_read_b128 v[92:95], v2 offset:49152
  v_mfma_f32_16x16x32_bf16 v[156:159], v[36:39], v[20:23], v[156:159]
  v_mfma_f32_16x16x32_bf16 v[160:163], v[40:43], v[8:11], v[160:163]
  v_mfma_f32_16x16x32_bf16 v[164:167], v[40:43], v[12:15], v[164:167]
  v_mfma_f32_16x16x32_bf16 v[168:171], v[40:43], v[16:19], v[168:171]
  v_mfma_f32_16x16x32_bf16 v[172:175], v[40:43], v[20:23], v[172:175]
  v_mfma_f32_16x16x32_bf16 v[176:179], v[44:47], v[8:11], v[176:179]
  v_mfma_f32_16x16x32_bf16 v[180:183], v[44:47], v[12:15], v[180:183]
  v_mfma_f32_16x16x32_bf16 v[184:187], v[44:47], v[16:19], v[184:187]
  v_mfma_f32_16x16x32_bf16 v[188:191], v[44:47], v[20:23], v[188:191]
  v_mfma_f32_16x16x32_bf16 v[192:195], v[48:51], v[8:11], v[192:195]
  v_mfma_f32_16x16x32_bf16 v[196:199], v[48:51], v[12:15], v[196:199]
  v_mfma_f32_16x16x32_bf16 v[200:203], v[48:51], v[16:19], v[200:203]
  v_mfma_f32_16x16x32_bf16 v[204:207], v[48:51], v[20:23], v[204:207]
  s_waitcnt lgkmcnt(0)
  v_mfma_f32_16x16x32_bf16 v[96:99], v[68:71], v[52:55], v[96:99]
  s_barrier
  ds_read_b128 v[8:11], v7 offset:0
  v_mfma_f32_16x16x32_bf16 v[100:103], v[68:71], v[56:59], v[100:103]
  ds_read_b128 v[12:15], v7 offset:256
  v_mfma_f32_16x16x32_bf16 v[104:107], v[68:71], v[60:63], v[104:107]
  ds_read_b128 v[16:19], v7 offset:512
  v_mfma_f32_16x16x32_bf16 v[108:111], v[68:71], v[64:67], v[108:111]
  ds_read_b128 v[20:23], v7 offset:768
  v_mfma_f32_16x16x32_bf16 v[112:115], v[72:75], v[52:55], v[112:115]
  ds_read_b128 v[24:27], v0 offset:0
  v_mfma_f32_16x16x32_bf16 v[116:119], v[72:75], v[56:59], v[116:119]
  ds_read_b128 v[28:31], v0 offset:64
  v_mfma_f32_16x16x32_bf16 v[120:123], v[72:75], v[60:63], v[120:123]
  ds_read_b128 v[32:35], v0 offset:128
  v_mfma_f32_16x16x32_bf16 v[124:127], v[72:75], v[64:67], v[124:127]
  ds_read_b128 v[36:39], v0 offset:192
  v_mfma_f32_16x16x32_bf16 v[128:131], v[76:79], v[52:55], v[128:131]
  ds_read_b128 v[40:43], v0 offset:256
  v_mfma_f32_16x16x32_bf16 v[132:135], v[76:79], v[56:59], v[132:135]
  ds_read_b128 v[44:47], v0 offset:320
  v_mfma_f32_16x16x32_bf16 v[136:139], v[76:79], v[60:63], v[136:139]
  ds_read_b128 v[48:51], v0 offset:384
  v_mfma_f32_16x16x32_bf16 v[140:143], v[76:79], v[64:67], v[140:143]
  v_mfma_f32_16x16x32_bf16 v[144:147], v[80:83], v[52:55], v[144:147]
  v_mfma_f32_16x16x32_bf16 v[148:151], v[80:83], v[56:59], v[148:151]
  v_mfma_f32_16x16x32_bf16 v[152:155], v[80:83], v[60:63], v[152:155]
  v_mfma_f32_16x16x32_bf16 v[156:159], v[80:83], v[64:67], v[156:159]
  v_mfma_f32_16x16x32_bf16 v[160:163], v[84:87], v[52:55], v[160:163]
  v_mfma_f32_16x16x32_bf16 v[164:167], v[84:87], v[56:59], v[164:167]
  v_mfma_f32_16x16x32_bf16 v[168:171], v[84:87], v[60:63], v[168:171]
  v_mfma_f32_16x16x32_bf16 v[172:175], v[84:87], v[64:67], v[172:175]
  v_mfma_f32_16x16x32_bf16 v[176:179], v[88:91], v[52:55], v[176:179]
  v_mfma_f32_16x16x32_bf16 v[180:183], v[88:91], v[56:59], v[180:183]
  v_mfma_f32_16x16x32_bf16 v[184:187], v[88:91], v[60:63], v[184:187]
  v_mfma_f32_16x16x32_bf16 v[188:191], v[88:91], v[64:67], v[188:191]
  v_mfma_f32_16x16x32_bf16 v[192:195], v[92:95], v[52:55], v[192:195]
  v_mfma_f32_16x16x32_bf16 v[196:199], v[92:95], v[56:59], v[196:199]
  v_mfma_f32_16x16x32_bf16 v[200:203], v[92:95], v[60:63], v[200:203]
  v_mfma_f32_16x16x32_bf16 v[204:207], v[92:95], v[64:67], v[204:207]
  s_setprio 1
  buffer_load_dwordx4 v[52:55], v1, s[8:11], s4 offen offset:0
  buffer_load_dwordx4 v[56:59], v1, s[8:11], s4 offen offset:1024
  buffer_load_dwordx4 v[60:63], v1, s[8:11], s4 offen offset:2048
  buffer_load_dwordx4 v[64:67], v1, s[8:11], s4 offen offset:3072
  buffer_load_dwordx4 v[68:71], v1, s[8:11], s5 offen offset:0
  buffer_load_dwordx4 v[72:75], v1, s[8:11], s5 offen offset:1024
  buffer_load_dwordx4 v[76:79], v1, s[8:11], s5 offen offset:2048
  buffer_load_dwordx4 v[80:83], v1, s[8:11], s5 offen offset:3072
  buffer_load_dwordx4 v[84:87], v1, s[8:11], s6 offen offset:0
  buffer_load_dwordx4 v[88:91], v1, s[8:11], s6 offen offset:1024
  buffer_load_dwordx4 v[92:95], v1, s[8:11], s6 offen offset:2048
  s_waitcnt lgkmcnt(0)
  v_pk_fma_f32 v[96:97], v[24:25], v[8:9], v[96:97] op_sel_hi:[1,0,1]
  v_pk_fma_f32 v[100:101], v[24:25], v[12:13], v[100:101] op_sel_hi:[1,0,1]
  v_pk_fma_f32 v[104:105], v[24:25], v[16:17], v[104:105] op_sel_hi:[1,0,1]
  v_pk_fma_f32 v[108:109], v[24:25], v[20:21], v[108:109] op_sel_hi:[1,0,1]
  v_pk_mul_f32 v[96:97], v[96:97], v[10:11] op_sel_hi:[1,0]
  v_pk_mul_f32 v[100:101], v[100:101], v[14:15] op_sel_hi:[1,0]
  v_pk_mul_f32 v[104:105], v[104:105], v[18:19] op_sel_hi:[1,0]
  v_pk_mul_f32 v[108:109], v[108:109], v[22:23] op_sel_hi:[1,0]
  v_exp_f32 v96, v96
  v_exp_f32 v97, v97
  v_pk_fma_f32 v[98:99], v[26:27], v[8:9], v[98:99] op_sel_hi:[1,0,1]
  v_exp_f32 v100, v100
  v_exp_f32 v101, v101
  v_pk_fma_f32 v[102:103], v[26:27], v[12:13], v[102:103] op_sel_hi:[1,0,1]
  v_exp_f32 v104, v104
  v_exp_f32 v105, v105
  v_pk_fma_f32 v[106:107], v[26:27], v[16:17], v[106:107] op_sel_hi:[1,0,1]
  v_exp_f32 v108, v108
  v_exp_f32 v109, v109
  v_pk_fma_f32 v[110:111], v[26:27], v[20:21], v[110:111] op_sel_hi:[1,0,1]
  v_pk_fma_f32 v[96:97], v[96:97], v[8:9], v[8:9] op_sel:[0,1,1] op_sel_hi:[1,1,1]
  v_pk_fma_f32 v[100:101], v[100:101], v[12:13], v[12:13] op_sel:[0,1,1] op_sel_hi:[1,1,1]
  v_pk_fma_f32 v[104:105], v[104:105], v[16:17], v[16:17] op_sel:[0,1,1] op_sel_hi:[1,1,1]
  v_pk_fma_f32 v[108:109], v[108:109], v[20:21], v[20:21] op_sel:[0,1,1] op_sel_hi:[1,1,1]
  v_rcp_f32 v96, v96
  v_rcp_f32 v97, v97
  v_rcp_f32 v100, v100
  v_rcp_f32 v101, v101
  v_rcp_f32 v104, v104
  v_rcp_f32 v105, v105
  v_rcp_f32 v108, v108
  v_rcp_f32 v109, v109
  v_pk_mul_f32 v[98:99], v[98:99], v[96:97]
  v_pk_mul_f32 v[102:103], v[102:103], v[100:101]
  v_pk_mul_f32 v[106:107], v[106:107], v[104:105]
  v_pk_mul_f32 v[110:111], v[110:111], v[108:109]
  v_cvt_pk_bf16_f32 v96, v98, v99
  v_cvt_pk_bf16_f32 v97, v102, v103
  v_cvt_pk_bf16_f32 v98, v106, v107
  v_cvt_pk_bf16_f32 v99, v110, v111
  v_permlane16_swap_b32 v96, v97
  s_nop 0
  v_permlane16_swap_b32 v98, v99
  s_nop 1
  v_permlane32_swap_b32 v96, v98
  v_permlane32_swap_b32 v97, v99
  buffer_store_dwordx4 v[96:99], v1, s[8:11], s38 offen offset:0 sc1
  v_pk_fma_f32 v[112:113], v[28:29], v[8:9], v[112:113] op_sel_hi:[1,0,1]
  v_pk_fma_f32 v[116:117], v[28:29], v[12:13], v[116:117] op_sel_hi:[1,0,1]
  v_pk_fma_f32 v[120:121], v[28:29], v[16:17], v[120:121] op_sel_hi:[1,0,1]
  v_pk_fma_f32 v[124:125], v[28:29], v[20:21], v[124:125] op_sel_hi:[1,0,1]
  v_pk_mul_f32 v[112:113], v[112:113], v[10:11] op_sel_hi:[1,0]
  v_pk_mul_f32 v[116:117], v[116:117], v[14:15] op_sel_hi:[1,0]
  v_pk_mul_f32 v[120:121], v[120:121], v[18:19] op_sel_hi:[1,0]
  v_pk_mul_f32 v[124:125], v[124:125], v[22:23] op_sel_hi:[1,0]
  v_exp_f32 v112, v112
  v_exp_f32 v113, v113
  v_pk_fma_f32 v[114:115], v[30:31], v[8:9], v[114:115] op_sel_hi:[1,0,1]
  v_exp_f32 v116, v116
  v_exp_f32 v117, v117
  v_pk_fma_f32 v[118:119], v[30:31], v[12:13], v[118:119] op_sel_hi:[1,0,1]
  v_exp_f32 v120, v120
  v_exp_f32 v121, v121
  v_pk_fma_f32 v[122:123], v[30:31], v[16:17], v[122:123] op_sel_hi:[1,0,1]
  v_exp_f32 v124, v124
  v_exp_f32 v125, v125
  v_pk_fma_f32 v[126:127], v[30:31], v[20:21], v[126:127] op_sel_hi:[1,0,1]
  v_pk_fma_f32 v[112:113], v[112:113], v[8:9], v[8:9] op_sel:[0,1,1] op_sel_hi:[1,1,1]
  v_pk_fma_f32 v[116:117], v[116:117], v[12:13], v[12:13] op_sel:[0,1,1] op_sel_hi:[1,1,1]
  v_pk_fma_f32 v[120:121], v[120:121], v[16:17], v[16:17] op_sel:[0,1,1] op_sel_hi:[1,1,1]
  v_pk_fma_f32 v[124:125], v[124:125], v[20:21], v[20:21] op_sel:[0,1,1] op_sel_hi:[1,1,1]
  v_rcp_f32 v112, v112
  v_rcp_f32 v113, v113
  v_rcp_f32 v116, v116
  v_rcp_f32 v117, v117
  v_rcp_f32 v120, v120
  v_rcp_f32 v121, v121
  v_rcp_f32 v124, v124
  v_rcp_f32 v125, v125
  v_pk_mul_f32 v[114:115], v[114:115], v[112:113]
  v_pk_mul_f32 v[118:119], v[118:119], v[116:117]
  v_pk_mul_f32 v[122:123], v[122:123], v[120:121]
  v_pk_mul_f32 v[126:127], v[126:127], v[124:125]
  v_cvt_pk_bf16_f32 v112, v114, v115
  v_cvt_pk_bf16_f32 v113, v118, v119
  v_cvt_pk_bf16_f32 v114, v122, v123
  v_cvt_pk_bf16_f32 v115, v126, v127
  v_permlane16_swap_b32 v112, v113
  s_nop 0
  v_permlane16_swap_b32 v114, v115
  s_nop 1
  v_permlane32_swap_b32 v112, v114
  v_permlane32_swap_b32 v113, v115
  buffer_store_dwordx4 v[112:115], v1, s[8:11], s38 offen offset:1024 sc1
  v_pk_fma_f32 v[128:129], v[32:33], v[8:9], v[128:129] op_sel_hi:[1,0,1]
  v_pk_fma_f32 v[132:133], v[32:33], v[12:13], v[132:133] op_sel_hi:[1,0,1]
  v_pk_fma_f32 v[136:137], v[32:33], v[16:17], v[136:137] op_sel_hi:[1,0,1]
  v_pk_fma_f32 v[140:141], v[32:33], v[20:21], v[140:141] op_sel_hi:[1,0,1]
  v_pk_mul_f32 v[128:129], v[128:129], v[10:11] op_sel_hi:[1,0]
  v_pk_mul_f32 v[132:133], v[132:133], v[14:15] op_sel_hi:[1,0]
  v_pk_mul_f32 v[136:137], v[136:137], v[18:19] op_sel_hi:[1,0]
  v_pk_mul_f32 v[140:141], v[140:141], v[22:23] op_sel_hi:[1,0]
  v_exp_f32 v128, v128
  v_exp_f32 v129, v129
  v_pk_fma_f32 v[130:131], v[34:35], v[8:9], v[130:131] op_sel_hi:[1,0,1]
  v_exp_f32 v132, v132
  v_exp_f32 v133, v133
  v_pk_fma_f32 v[134:135], v[34:35], v[12:13], v[134:135] op_sel_hi:[1,0,1]
  v_exp_f32 v136, v136
  v_exp_f32 v137, v137
  v_pk_fma_f32 v[138:139], v[34:35], v[16:17], v[138:139] op_sel_hi:[1,0,1]
  v_exp_f32 v140, v140
  v_exp_f32 v141, v141
  v_pk_fma_f32 v[142:143], v[34:35], v[20:21], v[142:143] op_sel_hi:[1,0,1]
  v_pk_fma_f32 v[128:129], v[128:129], v[8:9], v[8:9] op_sel:[0,1,1] op_sel_hi:[1,1,1]
  v_pk_fma_f32 v[132:133], v[132:133], v[12:13], v[12:13] op_sel:[0,1,1] op_sel_hi:[1,1,1]
  v_pk_fma_f32 v[136:137], v[136:137], v[16:17], v[16:17] op_sel:[0,1,1] op_sel_hi:[1,1,1]
  v_pk_fma_f32 v[140:141], v[140:141], v[20:21], v[20:21] op_sel:[0,1,1] op_sel_hi:[1,1,1]
  v_rcp_f32 v128, v128
  v_rcp_f32 v129, v129
  v_rcp_f32 v132, v132
  v_rcp_f32 v133, v133
  v_rcp_f32 v136, v136
  v_rcp_f32 v137, v137
  v_rcp_f32 v140, v140
  v_rcp_f32 v141, v141
  v_pk_mul_f32 v[130:131], v[130:131], v[128:129]
  v_pk_mul_f32 v[134:135], v[134:135], v[132:133]
  v_pk_mul_f32 v[138:139], v[138:139], v[136:137]
  v_pk_mul_f32 v[142:143], v[142:143], v[140:141]
  v_cvt_pk_bf16_f32 v128, v130, v131
  v_cvt_pk_bf16_f32 v129, v134, v135
  v_cvt_pk_bf16_f32 v130, v138, v139
  v_cvt_pk_bf16_f32 v131, v142, v143
  v_permlane16_swap_b32 v128, v129
  s_nop 0
  v_permlane16_swap_b32 v130, v131
  s_nop 1
  v_permlane32_swap_b32 v128, v130
  v_permlane32_swap_b32 v129, v131
  buffer_store_dwordx4 v[128:131], v1, s[8:11], s38 offen offset:2048 sc1
  v_pk_fma_f32 v[144:145], v[36:37], v[8:9], v[144:145] op_sel_hi:[1,0,1]
  v_pk_fma_f32 v[148:149], v[36:37], v[12:13], v[148:149] op_sel_hi:[1,0,1]
  v_pk_fma_f32 v[152:153], v[36:37], v[16:17], v[152:153] op_sel_hi:[1,0,1]
  v_pk_fma_f32 v[156:157], v[36:37], v[20:21], v[156:157] op_sel_hi:[1,0,1]
  v_pk_mul_f32 v[144:145], v[144:145], v[10:11] op_sel_hi:[1,0]
  v_pk_mul_f32 v[148:149], v[148:149], v[14:15] op_sel_hi:[1,0]
  v_pk_mul_f32 v[152:153], v[152:153], v[18:19] op_sel_hi:[1,0]
  v_pk_mul_f32 v[156:157], v[156:157], v[22:23] op_sel_hi:[1,0]
  v_exp_f32 v144, v144
  v_exp_f32 v145, v145
  v_pk_fma_f32 v[146:147], v[38:39], v[8:9], v[146:147] op_sel_hi:[1,0,1]
  v_exp_f32 v148, v148
  v_exp_f32 v149, v149
  v_pk_fma_f32 v[150:151], v[38:39], v[12:13], v[150:151] op_sel_hi:[1,0,1]
  v_exp_f32 v152, v152
  v_exp_f32 v153, v153
  v_pk_fma_f32 v[154:155], v[38:39], v[16:17], v[154:155] op_sel_hi:[1,0,1]
  v_exp_f32 v156, v156
  v_exp_f32 v157, v157
  v_pk_fma_f32 v[158:159], v[38:39], v[20:21], v[158:159] op_sel_hi:[1,0,1]
  v_pk_fma_f32 v[144:145], v[144:145], v[8:9], v[8:9] op_sel:[0,1,1] op_sel_hi:[1,1,1]
  v_pk_fma_f32 v[148:149], v[148:149], v[12:13], v[12:13] op_sel:[0,1,1] op_sel_hi:[1,1,1]
  v_pk_fma_f32 v[152:153], v[152:153], v[16:17], v[16:17] op_sel:[0,1,1] op_sel_hi:[1,1,1]
  v_pk_fma_f32 v[156:157], v[156:157], v[20:21], v[20:21] op_sel:[0,1,1] op_sel_hi:[1,1,1]
  v_rcp_f32 v144, v144
  v_rcp_f32 v145, v145
  v_rcp_f32 v148, v148
  v_rcp_f32 v149, v149
  v_rcp_f32 v152, v152
  v_rcp_f32 v153, v153
  v_rcp_f32 v156, v156
  v_rcp_f32 v157, v157
  v_pk_mul_f32 v[146:147], v[146:147], v[144:145]
  v_pk_mul_f32 v[150:151], v[150:151], v[148:149]
  v_pk_mul_f32 v[154:155], v[154:155], v[152:153]
  v_pk_mul_f32 v[158:159], v[158:159], v[156:157]
  v_cvt_pk_bf16_f32 v144, v146, v147
  v_cvt_pk_bf16_f32 v145, v150, v151
  v_cvt_pk_bf16_f32 v146, v154, v155
  v_cvt_pk_bf16_f32 v147, v158, v159
  v_permlane16_swap_b32 v144, v145
  s_nop 0
  v_permlane16_swap_b32 v146, v147
  s_nop 1
  v_permlane32_swap_b32 v144, v146
  v_permlane32_swap_b32 v145, v147
  buffer_store_dwordx4 v[144:147], v1, s[8:11], s38 offen offset:3072 sc1
  s_add_u32 s38, s38, 4096
  v_pk_fma_f32 v[160:161], v[40:41], v[8:9], v[160:161] op_sel_hi:[1,0,1]
  v_pk_fma_f32 v[164:165], v[40:41], v[12:13], v[164:165] op_sel_hi:[1,0,1]
  v_pk_fma_f32 v[168:169], v[40:41], v[16:17], v[168:169] op_sel_hi:[1,0,1]
  v_pk_fma_f32 v[172:173], v[40:41], v[20:21], v[172:173] op_sel_hi:[1,0,1]
  v_pk_mul_f32 v[160:161], v[160:161], v[10:11] op_sel_hi:[1,0]
  v_pk_mul_f32 v[164:165], v[164:165], v[14:15] op_sel_hi:[1,0]
  v_pk_mul_f32 v[168:169], v[168:169], v[18:19] op_sel_hi:[1,0]
  v_pk_mul_f32 v[172:173], v[172:173], v[22:23] op_sel_hi:[1,0]
  v_exp_f32 v160, v160
  v_exp_f32 v161, v161
  v_pk_fma_f32 v[162:163], v[42:43], v[8:9], v[162:163] op_sel_hi:[1,0,1]
  v_exp_f32 v164, v164
  v_exp_f32 v165, v165
  v_pk_fma_f32 v[166:167], v[42:43], v[12:13], v[166:167] op_sel_hi:[1,0,1]
  v_exp_f32 v168, v168
  v_exp_f32 v169, v169
  v_pk_fma_f32 v[170:171], v[42:43], v[16:17], v[170:171] op_sel_hi:[1,0,1]
  v_exp_f32 v172, v172
  v_exp_f32 v173, v173
  v_pk_fma_f32 v[174:175], v[42:43], v[20:21], v[174:175] op_sel_hi:[1,0,1]
  v_pk_fma_f32 v[160:161], v[160:161], v[8:9], v[8:9] op_sel:[0,1,1] op_sel_hi:[1,1,1]
  v_pk_fma_f32 v[164:165], v[164:165], v[12:13], v[12:13] op_sel:[0,1,1] op_sel_hi:[1,1,1]
  v_pk_fma_f32 v[168:169], v[168:169], v[16:17], v[16:17] op_sel:[0,1,1] op_sel_hi:[1,1,1]
  v_pk_fma_f32 v[172:173], v[172:173], v[20:21], v[20:21] op_sel:[0,1,1] op_sel_hi:[1,1,1]
  v_rcp_f32 v160, v160
  v_rcp_f32 v161, v161
  v_rcp_f32 v164, v164
  v_rcp_f32 v165, v165
  v_rcp_f32 v168, v168
  v_rcp_f32 v169, v169
  v_rcp_f32 v172, v172
  v_rcp_f32 v173, v173
  v_pk_mul_f32 v[162:163], v[162:163], v[160:161]
  v_pk_mul_f32 v[166:167], v[166:167], v[164:165]
  v_pk_mul_f32 v[170:171], v[170:171], v[168:169]
  v_pk_mul_f32 v[174:175], v[174:175], v[172:173]
  v_cvt_pk_bf16_f32 v160, v162, v163
  v_cvt_pk_bf16_f32 v161, v166, v167
  v_cvt_pk_bf16_f32 v162, v170, v171
  v_cvt_pk_bf16_f32 v163, v174, v175
  v_permlane16_swap_b32 v160, v161
  s_nop 0
  v_permlane16_swap_b32 v162, v163
  s_nop 1
  v_permlane32_swap_b32 v160, v162
  v_permlane32_swap_b32 v161, v163
  buffer_store_dwordx4 v[160:163], v1, s[8:11], s38 offen offset:0 sc1
  v_pk_fma_f32 v[176:177], v[44:45], v[8:9], v[176:177] op_sel_hi:[1,0,1]
  v_pk_fma_f32 v[180:181], v[44:45], v[12:13], v[180:181] op_sel_hi:[1,0,1]
  v_pk_fma_f32 v[184:185], v[44:45], v[16:17], v[184:185] op_sel_hi:[1,0,1]
  v_pk_fma_f32 v[188:189], v[44:45], v[20:21], v[188:189] op_sel_hi:[1,0,1]
  v_pk_mul_f32 v[176:177], v[176:177], v[10:11] op_sel_hi:[1,0]
  v_pk_mul_f32 v[180:181], v[180:181], v[14:15] op_sel_hi:[1,0]
  v_pk_mul_f32 v[184:185], v[184:185], v[18:19] op_sel_hi:[1,0]
  v_pk_mul_f32 v[188:189], v[188:189], v[22:23] op_sel_hi:[1,0]
  v_exp_f32 v176, v176
  v_exp_f32 v177, v177
  v_pk_fma_f32 v[178:179], v[46:47], v[8:9], v[178:179] op_sel_hi:[1,0,1]
  v_exp_f32 v180, v180
  v_exp_f32 v181, v181
  v_pk_fma_f32 v[182:183], v[46:47], v[12:13], v[182:183] op_sel_hi:[1,0,1]
  v_exp_f32 v184, v184
  v_exp_f32 v185, v185
  v_pk_fma_f32 v[186:187], v[46:47], v[16:17], v[186:187] op_sel_hi:[1,0,1]
  v_exp_f32 v188, v188
  v_exp_f32 v189, v189
  v_pk_fma_f32 v[190:191], v[46:47], v[20:21], v[190:191] op_sel_hi:[1,0,1]
  v_pk_fma_f32 v[176:177], v[176:177], v[8:9], v[8:9] op_sel:[0,1,1] op_sel_hi:[1,1,1]
  v_pk_fma_f32 v[180:181], v[180:181], v[12:13], v[12:13] op_sel:[0,1,1] op_sel_hi:[1,1,1]
  v_pk_fma_f32 v[184:185], v[184:185], v[16:17], v[16:17] op_sel:[0,1,1] op_sel_hi:[1,1,1]
  v_pk_fma_f32 v[188:189], v[188:189], v[20:21], v[20:21] op_sel:[0,1,1] op_sel_hi:[1,1,1]
  v_rcp_f32 v176, v176
  v_rcp_f32 v177, v177
  v_rcp_f32 v180, v180
  v_rcp_f32 v181, v181
  v_rcp_f32 v184, v184
  v_rcp_f32 v185, v185
  v_rcp_f32 v188, v188
  v_rcp_f32 v189, v189
  v_pk_mul_f32 v[178:179], v[178:179], v[176:177]
  v_pk_mul_f32 v[182:183], v[182:183], v[180:181]
  v_pk_mul_f32 v[186:187], v[186:187], v[184:185]
  v_pk_mul_f32 v[190:191], v[190:191], v[188:189]
  v_cvt_pk_bf16_f32 v176, v178, v179
  v_cvt_pk_bf16_f32 v177, v182, v183
  v_cvt_pk_bf16_f32 v178, v186, v187
  v_cvt_pk_bf16_f32 v179, v190, v191
  v_permlane16_swap_b32 v176, v177
  s_nop 0
  v_permlane16_swap_b32 v178, v179
  s_nop 1
  v_permlane32_swap_b32 v176, v178
  v_permlane32_swap_b32 v177, v179
  buffer_store_dwordx4 v[176:179], v1, s[8:11], s38 offen offset:1024 sc1
  v_pk_fma_f32 v[192:193], v[48:49], v[8:9], v[192:193] op_sel_hi:[1,0,1]
  v_pk_fma_f32 v[196:197], v[48:49], v[12:13], v[196:197] op_sel_hi:[1,0,1]
  v_pk_fma_f32 v[200:201], v[48:49], v[16:17], v[200:201] op_sel_hi:[1,0,1]
  v_pk_fma_f32 v[204:205], v[48:49], v[20:21], v[204:205] op_sel_hi:[1,0,1]
  v_pk_mul_f32 v[192:193], v[192:193], v[10:11] op_sel_hi:[1,0]
  v_pk_mul_f32 v[196:197], v[196:197], v[14:15] op_sel_hi:[1,0]
  v_pk_mul_f32 v[200:201], v[200:201], v[18:19] op_sel_hi:[1,0]
  v_pk_mul_f32 v[204:205], v[204:205], v[22:23] op_sel_hi:[1,0]
  v_exp_f32 v192, v192
  v_exp_f32 v193, v193
  v_pk_fma_f32 v[194:195], v[50:51], v[8:9], v[194:195] op_sel_hi:[1,0,1]
  v_exp_f32 v196, v196
  v_exp_f32 v197, v197
  v_pk_fma_f32 v[198:199], v[50:51], v[12:13], v[198:199] op_sel_hi:[1,0,1]
  v_exp_f32 v200, v200
  v_exp_f32 v201, v201
  v_pk_fma_f32 v[202:203], v[50:51], v[16:17], v[202:203] op_sel_hi:[1,0,1]
  v_exp_f32 v204, v204
  v_exp_f32 v205, v205
  v_pk_fma_f32 v[206:207], v[50:51], v[20:21], v[206:207] op_sel_hi:[1,0,1]
  v_pk_fma_f32 v[192:193], v[192:193], v[8:9], v[8:9] op_sel:[0,1,1] op_sel_hi:[1,1,1]
  v_pk_fma_f32 v[196:197], v[196:197], v[12:13], v[12:13] op_sel:[0,1,1] op_sel_hi:[1,1,1]
  v_pk_fma_f32 v[200:201], v[200:201], v[16:17], v[16:17] op_sel:[0,1,1] op_sel_hi:[1,1,1]
  v_pk_fma_f32 v[204:205], v[204:205], v[20:21], v[20:21] op_sel:[0,1,1] op_sel_hi:[1,1,1]
  v_rcp_f32 v192, v192
  v_rcp_f32 v193, v193
  v_rcp_f32 v196, v196
  v_rcp_f32 v197, v197
  v_rcp_f32 v200, v200
  v_rcp_f32 v201, v201
  v_rcp_f32 v204, v204
  v_rcp_f32 v205, v205
  v_pk_mul_f32 v[194:195], v[194:195], v[192:193]
  v_pk_mul_f32 v[198:199], v[198:199], v[196:197]
  v_pk_mul_f32 v[202:203], v[202:203], v[200:201]
  v_pk_mul_f32 v[206:207], v[206:207], v[204:205]
  v_cvt_pk_bf16_f32 v192, v194, v195
  v_cvt_pk_bf16_f32 v193, v198, v199
  v_cvt_pk_bf16_f32 v194, v202, v203
  v_cvt_pk_bf16_f32 v195, v206, v207
  v_permlane16_swap_b32 v192, v193
  s_nop 0
  v_permlane16_swap_b32 v194, v195
  s_nop 1
  v_permlane32_swap_b32 v192, v194
  v_permlane32_swap_b32 v193, v195
  buffer_store_dwordx4 v[192:195], v1, s[8:11], s38 offen offset:2048 sc1
  v_lshrrev_b32 v0, 4, v1
  v_lshrrev_b32 v4, 5, v0
  v_and_b32 v5, 31, v0
  v_lshlrev_b32 v2, 4, v5
  v_lshl_add_u32 v2, v4, 10, v2
  s_lshl_b32 s24, s63, 13
  v_add_u32 v2, s24, v2
  v_add_u32 v3, 65536, v2
  s_and_b32 s24, s63, 1
  s_lshl_b32 s24, s24, 4
  v_lshlrev_b32 v6, 3, v4
  v_add_u32 v6, s24, v6
  v_sub_u32 v6, v5, v6
  v_mov_b32 v7, 0x3f80
  v_mov_b32 v12, 0x3f800000
  v_cmp_eq_u32 vcc, 0, v6
  v_cmp_eq_u32 s[26:27], 1, v6
  s_nop 0
  v_cndmask_b32 v8, 0, v7, vcc
  v_cndmask_b32 v8, v8, v12, s[26:27]
  v_cmp_eq_u32 vcc, 2, v6
  v_cmp_eq_u32 s[26:27], 3, v6
  s_nop 0
  v_cndmask_b32 v9, 0, v7, vcc
  v_cndmask_b32 v9, v9, v12, s[26:27]
  v_cmp_eq_u32 vcc, 4, v6
  v_cmp_eq_u32 s[26:27], 5, v6
  s_nop 0
  v_cndmask_b32 v10, 0, v7, vcc
  v_cndmask_b32 v10, v10, v12, s[26:27]
  v_cmp_eq_u32 vcc, 6, v6
  v_cmp_eq_u32 s[26:27], 7, v6
  s_nop 0
  v_cndmask_b32 v11, 0, v7, vcc
  v_cndmask_b32 v11, v11, v12, s[26:27]
  v_bfe_u32 v6, v0, 2, 2
  v_lshl_add_u32 v7, v4, 3, v6
  v_lshlrev_b32 v7, 7, v7
  v_and_b32 v6, 1, v6
  s_lshr_b32 s25, s63, 1
  v_xor_b32 v6, s25, v6
  v_lshl_add_u32 v7, v6, 6, v7
  v_bfe_u32 v6, v0, 4, 1
  v_xor_b32 v6, v6, v4
  v_lshl_add_u32 v7, v6, 5, v7
  v_and_b32 v6, 3, v0
  v_lshl_add_u32 v7, v6, 3, v7
  s_lshl_b32 s24, s24, 7
  s_lshl_b32 s26, s62, 12
  s_add_u32 s24, s24, s26
  s_add_u32 s24, s24, 131072
  v_add_u32 v6, s24, v7
  v_mov_b64 v[176:177], 0
  v_mov_b64 v[178:179], 0
  v_mov_b64 v[180:181], 0
  v_mov_b64 v[182:183], 0
  v_mov_b64 v[184:185], 0
  v_mov_b64 v[186:187], 0
  v_mov_b64 v[188:189], 0
  v_mov_b64 v[190:191], 0
  v_mov_b64 v[192:193], 0
  v_mov_b64 v[194:195], 0
  v_mov_b64 v[196:197], 0
  v_mov_b64 v[198:199], 0
  v_mov_b64 v[200:201], 0
  v_mov_b64 v[202:203], 0
  v_mov_b64 v[204:205], 0
  v_mov_b64 v[206:207], 0
  v_lshrrev_b32 v12, 4, v0
  s_lshl_b32 s24, s3, 2
  v_add_u32 v12, s24, v12
  v_bfe_u32 v13, v0, 3, 1
  v_bfe_u32 v14, v0, 2, 1
  v_and_b32 v15, 3, v0
  v_lshlrev_b32 v4, 8, v12
  v_lshl_add_u32 v4, v13, 7, v4
  v_lshl_add_u32 v4, v15, 5, v4
  v_mul_u32_u24 v14, 8208, v14
  v_add_u32 v4, v4, v14
  v_lshrrev_b32 v14, 4, v12
  v_lshlrev_b32 v5, 5, v14
  v_lshl_add_u32 v5, v13, 4, v5
  v_and_b32 v14, 3, v12
  v_lshl_add_u32 v5, v14, 2, v5
  v_bfe_u32 v14, v12, 2, 2
  v_add_u32 v5, v5, v14
  v_lshlrev_b32 v5, 10, v5
  v_and_b32 v14, 7, v0
  v_lshl_add_u32 v5, v14, 4, v5
  s_lshl_b32 s34, s59, 16
  s_lshl_b32 s24, s61, 7
  s_add_u32 s34, s34, s24
  s_mul_i32 s33, s3, 8208
  s_lshl_b32 s31, s3, 12
  v_mov_b32 v49, 1
  s_mov_b64 exec, 1
  s_waitcnt vmcnt(0)
  buffer_store_dword v49, v1, s[8:11], s39 offen sc1
  s_mov_b64 exec, -1
  s_barrier
  s_setprio 0
  buffer_load_dwordx4 v[96:99], v1, s[8:11], s6 offen offset:3072
  buffer_load_dwordx4 v[100:103], v1, s[8:11], s7 offen offset:0
  buffer_load_dwordx4 v[104:107], v1, s[8:11], s7 offen offset:1024
  buffer_load_dwordx4 v[108:111], v1, s[8:11], s7 offen offset:2048
  buffer_load_dwordx4 v[112:115], v1, s[8:11], s7 offen offset:3072
  buffer_load_dwordx4 v[208:211], v1, s[8:11], s28 offen offset:0
  buffer_load_dwordx4 v[212:215], v1, s[8:11], s28 offen offset:1024
  buffer_load_dwordx4 v[216:219], v1, s[8:11], s28 offen offset:2048
  buffer_load_dwordx4 v[220:223], v1, s[8:11], s28 offen offset:3072
  buffer_load_dwordx4 v[224:227], v1, s[8:11], s29 offen offset:0
  buffer_load_dwordx4 v[228:231], v1, s[8:11], s29 offen offset:1024
  buffer_load_dwordx4 v[232:235], v1, s[8:11], s29 offen offset:2048
  buffer_load_dwordx4 v[236:239], v1, s[8:11], s29 offen offset:3072
  buffer_load_dwordx4 v[240:243], v1, s[8:11], s32 offen offset:0
  buffer_load_dwordx4 v[244:247], v1, s[8:11], s32 offen offset:1024
  buffer_load_dwordx4 v[248:251], v1, s[8:11], s32 offen offset:2048
  buffer_load_dwordx4 v[252:255], v1, s[8:11], s32 offen offset:3072
k3_p2:
  s_barrier
  s_add_u32 m0, s31, 32768
  s_nop 0
  buffer_load_dwordx4 v1, s[8:11], s53 offen offset:0 sc1 lds
  buffer_load_dwordx4 v1, s[8:11], s53 offen offset:1024 sc1 lds
  s_barrier
  s_add_u32 m0, s31, 32768
  s_nop 0
  buffer_load_dwordx4 v1, s[8:11], s53 offen offset:2048 sc1 lds
  buffer_load_dwordx4 v1, s[8:11], s53 offen offset:3072 sc1 lds
  s_add_u32 s53, s53, 8192
  s_barrier
  s_add_u32 m0, s31, 65536
  s_nop 0
  buffer_load_dwordx4 v1, s[8:11], s53 offen offset:0 sc1 lds
  buffer_load_dwordx4 v1, s[8:11], s53 offen offset:1024 sc1 lds
  s_barrier
  s_add_u32 m0, s31, 65536
  s_nop 0
  buffer_load_dwordx4 v1, s[8:11], s53 offen offset:2048 sc1 lds
  buffer_load_dwordx4 v1, s[8:11], s53 offen offset:3072 sc1 lds
  s_add_u32 s53, s53, 8192
  s_waitcnt vmcnt(6)
  s_barrier
  ds_read_b64_tr_b16 v[12:13], v6
  ds_read_b64_tr_b16 v[14:15], v6 offset:512
  ds_read_b128 v[16:19], v2 offset:32768
  ds_read_b128 v[20:23], v2 offset:33280
  ds_read_b128 v[24:27], v2 offset:36864
  ds_read_b128 v[28:31], v2 offset:37376
  s_add_u32 m0, s31, 98304
  s_nop 0
  buffer_load_dwordx4 v1, s[8:11], s53 offen offset:0 sc1 lds
  buffer_load_dwordx4 v1, s[8:11], s53 offen offset:1024 sc1 lds
  s_waitcnt lgkmcnt(4)
  s_cmp_ge_u32 s63, 2
  s_cbranch_scc1 k3_z1
  v_mfma_f32_32x32x16_bf16 v[176:191], v[12:15], v[8:11], v[176:191]
  s_branch k3_z2
k3_z1:
  v_mfma_f32_32x32x16_bf16 v[192:207], v[12:15], v[8:11], v[192:207]
k3_z2:
  s_waitcnt lgkmcnt(0)
  v_mfma_f32_32x32x16_bf16 v[176:191], v[16:19], v[52:55], v[176:191]
  v_mfma_f32_32x32x16_bf16 v[192:207], v[20:23], v[52:55], v[192:207]
  s_waitcnt vmcnt(6)
  s_barrier
  ds_read_b128 v[116:119], v2 offset:34816
  ds_read_b128 v[120:123], v2 offset:35328
  v_mfma_f32_32x32x16_bf16 v[176:191], v[24:27], v[60:63], v[176:191]
  ds_read_b128 v[124:127], v2 offset:38912
  ds_read_b128 v[128:131], v2 offset:39424
  v_mfma_f32_32x32x16_bf16 v[192:207], v[28:31], v[60:63], v[192:207]
  s_add_u32 m0, s31, 98304
  s_nop 0
  buffer_load_dwordx4 v1, s[8:11], s53 offen offset:2048 sc1 lds
  buffer_load_dwordx4 v1, s[8:11], s53 offen offset:3072 sc1 lds
  s_add_u32 s53, s53, 8192
  s_waitcnt lgkmcnt(0)
  v_mfma_f32_32x32x16_bf16 v[176:191], v[116:119], v[56:59], v[176:191]
  v_mfma_f32_32x32x16_bf16 v[192:207], v[120:123], v[56:59], v[192:207]
  s_waitcnt vmcnt(6)
  s_barrier
  ds_read_b128 v[16:19], v3 offset:0
  ds_read_b128 v[20:23], v3 offset:512
  v_mfma_f32_32x32x16_bf16 v[176:191], v[124:127], v[64:67], v[176:191]
  ds_read_b128 v[24:27], v3 offset:4096
  ds_read_b128 v[28:31], v3 offset:4608
  v_mfma_f32_32x32x16_bf16 v[192:207], v[128:131], v[64:67], v[192:207]
  s_add_u32 m0, s31, 0
  s_nop 0
  buffer_load_dwordx4 v1, s[8:11], s53 offen offset:0 sc1 lds
  buffer_load_dwordx4 v1, s[8:11], s53 offen offset:1024 sc1 lds
  s_waitcnt lgkmcnt(0)
  v_mfma_f32_32x32x16_bf16 v[176:191], v[16:19], v[68:71], v[176:191]
  v_mfma_f32_32x32x16_bf16 v[192:207], v[20:23], v[68:71], v[192:207]
  s_waitcnt vmcnt(6)
  s_barrier
  ds_read_b128 v[116:119], v3 offset:2048
  ds_read_b128 v[120:123], v3 offset:2560
  v_mfma_f32_32x32x16_bf16 v[176:191], v[24:27], v[76:79], v[176:191]
  ds_read_b128 v[124:127], v3 offset:6144
  ds_read_b128 v[128:131], v3 offset:6656
  v_mfma_f32_32x32x16_bf16 v[192:207], v[28:31], v[76:79], v[192:207]
  s_add_u32 m0, s31, 0
  s_nop 0
  buffer_load_dwordx4 v1, s[8:11], s53 offen offset:2048 sc1 lds
  buffer_load_dwordx4 v1, s[8:11], s53 offen offset:3072 sc1 lds
  s_add_u32 s53, s53, 8192
  s_waitcnt lgkmcnt(0)
  v_mfma_f32_32x32x16_bf16 v[176:191], v[116:119], v[72:75], v[176:191]
  v_mfma_f32_32x32x16_bf16 v[192:207], v[120:123], v[72:75], v[192:207]
  s_waitcnt vmcnt(6)
  s_barrier
  ds_read_b128 v[16:19], v3 offset:32768
  ds_read_b128 v[20:23], v3 offset:33280
  v_mfma_f32_32x32x16_bf16 v[176:191], v[124:127], v[80:83], v[176:191]
  ds_read_b128 v[24:27], v3 offset:36864
  ds_read_b128 v[28:31], v3 offset:37376
  v_mfma_f32_32x32x16_bf16 v[192:207], v[128:131], v[80:83], v[192:207]
  s_add_u32 m0, s31, 32768
  s_nop 0
  buffer_load_dwordx4 v1, s[8:11], s53 offen offset:0 sc1 lds
  buffer_load_dwordx4 v1, s[8:11], s53 offen offset:1024 sc1 lds
  s_waitcnt lgkmcnt(0)
  v_mfma_f32_32x32x16_bf16 v[176:191], v[16:19], v[84:87], v[176:191]
  v_mfma_f32_32x32x16_bf16 v[192:207], v[20:23], v[84:87], v[192:207]
  s_waitcnt vmcnt(6)
  s_barrier
  ds_read_b128 v[116:119], v3 offset:34816
  ds_read_b128 v[120:123], v3 offset:35328
  v_mfma_f32_32x32x16_bf16 v[176:191], v[24:27], v[92:95], v[176:191]
  ds_read_b128 v[124:127], v3 offset:38912
  ds_read_b128 v[128:131], v3 offset:39424
  v_mfma_f32_32x32x16_bf16 v[192:207], v[28:31], v[92:95], v[192:207]
  s_add_u32 m0, s31, 32768
  s_nop 0
  buffer_load_dwordx4 v1, s[8:11], s53 offen offset:2048 sc1 lds
  buffer_load_dwordx4 v1, s[8:11], s53 offen offset:3072 sc1 lds
  s_add_u32 s53, s53, 8192
  s_waitcnt lgkmcnt(0)
  v_mfma_f32_32x32x16_bf16 v[176:191], v[116:119], v[88:91], v[176:191]
  v_mfma_f32_32x32x16_bf16 v[192:207], v[120:123], v[88:91], v[192:207]
  s_waitcnt vmcnt(6)
  s_barrier
  ds_read_b128 v[16:19], v2 offset:0
  ds_read_b128 v[20:23], v2 offset:512
  v_mfma_f32_32x32x16_bf16 v[176:191], v[124:127], v[96:99], v[176:191]
  ds_read_b128 v[24:27], v2 offset:4096
  ds_read_b128 v[28:31], v2 offset:4608
  v_mfma_f32_32x32x16_bf16 v[192:207], v[128:131], v[96:99], v[192:207]
  s_add_u32 m0, s31, 65536
  s_nop 0
  buffer_load_dwordx4 v1, s[8:11], s53 offen offset:0 sc1 lds
  buffer_load_dwordx4 v1, s[8:11], s53 offen offset:1024 sc1 lds
  s_waitcnt lgkmcnt(0)
  v_mfma_f32_32x32x16_bf16 v[176:191], v[16:19], v[100:103], v[176:191]
  v_mfma_f32_32x32x16_bf16 v[192:207], v[20:23], v[100:103], v[192:207]
  s_waitcnt vmcnt(6)
  s_barrier
  ds_read_b128 v[116:119], v2 offset:2048
  ds_read_b128 v[120:123], v2 offset:2560
  v_mfma_f32_32x32x16_bf16 v[176:191], v[24:27], v[108:111], v[176:191]
  ds_read_b128 v[124:127], v2 offset:6144
  ds_read_b128 v[128:131], v2 offset:6656
  v_mfma_f32_32x32x16_bf16 v[192:207], v[28:31], v[108:111], v[192:207]
  s_add_u32 m0, s31, 65536
  s_nop 0
  buffer_load_dwordx4 v1, s[8:11], s53 offen offset:2048 sc1 lds
  buffer_load_dwordx4 v1, s[8:11], s53 offen offset:3072 sc1 lds
  s_add_u32 s53, s53, 8192
  s_waitcnt lgkmcnt(0)
  v_mfma_f32_32x32x16_bf16 v[176:191], v[116:119], v[104:107], v[176:191]
  v_mfma_f32_32x32x16_bf16 v[192:207], v[120:123], v[104:107], v[192:207]
  s_waitcnt vmcnt(6)
  s_barrier
  ds_read_b128 v[16:19], v2 offset:32768
  ds_read_b128 v[20:23], v2 offset:33280
  v_mfma_f32_32x32x16_bf16 v[176:191], v[124:127], v[112:115], v[176:191]
  ds_read_b128 v[24:27], v2 offset:36864
  ds_read_b128 v[28:31], v2 offset:37376
  v_mfma_f32_32x32x16_bf16 v[192:207], v[128:131], v[112:115], v[192:207]
  s_add_u32 m0, s31, 98304
  s_nop 0
  buffer_load_dwordx4 v1, s[8:11], s53 offen offset:0 sc1 lds
  buffer_load_dwordx4 v1, s[8:11], s53 offen offset:1024 sc1 lds
  s_waitcnt lgkmcnt(0)
  v_mfma_f32_32x32x16_bf16 v[176:191], v[16:19], v[208:211], v[176:191]
  v_mfma_f32_32x32x16_bf16 v[192:207], v[20:23], v[208:211], v[192:207]
  s_waitcnt vmcnt(6)
  s_barrier
  ds_read_b128 v[116:119], v2 offset:34816
  ds_read_b128 v[120:123], v2 offset:35328
  v_mfma_f32_32x32x16_bf16 v[176:191], v[24:27], v[216:219], v[176:191]
  ds_read_b128 v[124:127], v2 offset:38912
  ds_read_b128 v[128:131], v2 offset:39424
  v_mfma_f32_32x32x16_bf16 v[192:207], v[28:31], v[216:219], v[192:207]
  s_add_u32 m0, s31, 98304
  s_nop 0
  buffer_load_dwordx4 v1, s[8:11], s53 offen offset:2048 sc1 lds
  buffer_load_dwordx4 v1, s[8:11], s53 offen offset:3072 sc1 lds
  s_waitcnt lgkmcnt(0)
  v_mfma_f32_32x32x16_bf16 v[176:191], v[116:119], v[212:215], v[176:191]
  v_mfma_f32_32x32x16_bf16 v[192:207], v[120:123], v[212:215], v[192:207]
  s_waitcnt vmcnt(6)
  s_barrier
  ds_read_b128 v[16:19], v3 offset:0
  ds_read_b128 v[20:23], v3 offset:512
  v_mfma_f32_32x32x16_bf16 v[176:191], v[124:127], v[220:223], v[176:191]
  ds_read_b128 v[24:27], v3 offset:4096
  ds_read_b128 v[28:31], v3 offset:4608
  v_mfma_f32_32x32x16_bf16 v[192:207], v[128:131], v[220:223], v[192:207]
  s_waitcnt lgkmcnt(0)
  v_mfma_f32_32x32x16_bf16 v[176:191], v[16:19], v[224:227], v[176:191]
  v_mfma_f32_32x32x16_bf16 v[192:207], v[20:23], v[224:227], v[192:207]
  s_waitcnt vmcnt(4)
  s_barrier
  ds_read_b128 v[116:119], v3 offset:2048
  ds_read_b128 v[120:123], v3 offset:2560
  v_mfma_f32_32x32x16_bf16 v[176:191], v[24:27], v[232:235], v[176:191]
  ds_read_b128 v[124:127], v3 offset:6144
  ds_read_b128 v[128:131], v3 offset:6656
  v_mfma_f32_32x32x16_bf16 v[192:207], v[28:31], v[232:235], v[192:207]
  s_waitcnt lgkmcnt(0)
  v_mfma_f32_32x32x16_bf16 v[176:191], v[116:119], v[228:231], v[176:191]
  v_mfma_f32_32x32x16_bf16 v[192:207], v[120:123], v[228:231], v[192:207]
  s_waitcnt vmcnt(2)
  s_barrier
  ds_read_b128 v[16:19], v3 offset:32768
  ds_read_b128 v[20:23], v3 offset:33280
  v_mfma_f32_32x32x16_bf16 v[176:191], v[124:127], v[236:239], v[176:191]
  ds_read_b128 v[24:27], v3 offset:36864
  ds_read_b128 v[28:31], v3 offset:37376
  v_mfma_f32_32x32x16_bf16 v[192:207], v[128:131], v[236:239], v[192:207]
  s_waitcnt lgkmcnt(0)
  v_mfma_f32_32x32x16_bf16 v[176:191], v[16:19], v[240:243], v[176:191]
  v_mfma_f32_32x32x16_bf16 v[192:207], v[20:23], v[240:243], v[192:207]
  s_waitcnt vmcnt(0)
  s_barrier
  ds_read_b128 v[116:119], v3 offset:34816
  ds_read_b128 v[120:123], v3 offset:35328
  v_mfma_f32_32x32x16_bf16 v[176:191], v[24:27], v[248:251], v[176:191]
  ds_read_b128 v[124:127], v3 offset:38912
  ds_read_b128 v[128:131], v3 offset:39424
  v_mfma_f32_32x32x16_bf16 v[192:207], v[28:31], v[248:251], v[192:207]
  s_waitcnt lgkmcnt(3)
  v_mfma_f32_32x32x16_bf16 v[176:191], v[116:119], v[244:247], v[176:191]
  s_waitcnt lgkmcnt(2)
  v_mfma_f32_32x32x16_bf16 v[192:207], v[120:123], v[244:247], v[192:207]
  s_waitcnt lgkmcnt(1)
  v_mfma_f32_32x32x16_bf16 v[176:191], v[124:127], v[252:255], v[176:191]
  s_waitcnt lgkmcnt(0)
  v_mfma_f32_32x32x16_bf16 v[192:207], v[128:131], v[252:255], v[192:207]
  s_mov_b32 m0, s33
  s_nop 7
  s_nop 0
  ds_write_addtid_b32 v176 offset:0
  ds_write_addtid_b32 v177 offset:256
  ds_write_addtid_b32 v178 offset:512
  ds_write_addtid_b32 v179 offset:768
  ds_write_addtid_b32 v180 offset:1024
  ds_write_addtid_b32 v181 offset:1280
  ds_write_addtid_b32 v182 offset:1536
  ds_write_addtid_b32 v183 offset:1792
  ds_write_addtid_b32 v184 offset:2048
  ds_write_addtid_b32 v185 offset:2304
  ds_write_addtid_b32 v186 offset:2560
  ds_write_addtid_b32 v187 offset:2816
  ds_write_addtid_b32 v188 offset:3072
  ds_write_addtid_b32 v189 offset:3328
  ds_write_addtid_b32 v190 offset:3584
  ds_write_addtid_b32 v191 offset:3840
  ds_write_addtid_b32 v192 offset:4096
  ds_write_addtid_b32 v193 offset:4352
  ds_write_addtid_b32 v194 offset:4608
  ds_write_addtid_b32 v195 offset:4864
  ds_write_addtid_b32 v196 offset:5120
  ds_write_addtid_b32 v197 offset:5376
  ds_write_addtid_b32 v198 offset:5632
  ds_write_addtid_b32 v199 offset:5888
  ds_write_addtid_b32 v200 offset:6144
  ds_write_addtid_b32 v201 offset:6400
  ds_write_addtid_b32 v202 offset:6656
  ds_write_addtid_b32 v203 offset:6912
  ds_write_addtid_b32 v204 offset:7168
  ds_write_addtid_b32 v205 offset:7424
  ds_write_addtid_b32 v206 offset:7680
  ds_write_addtid_b32 v207 offset:7936
  s_waitcnt lgkmcnt(0)
  s_barrier
  ds_read_b128 v[16:19], v4 offset:0
  ds_read_b128 v[20:23], v4 offset:16
  ds_read_b128 v[24:27], v4 offset:16416
  ds_read_b128 v[28:31], v4 offset:16432
  ds_read_b128 v[32:35], v4 offset:32832
  ds_read_b128 v[36:39], v4 offset:32848
  ds_read_b128 v[40:43], v4 offset:49248
  ds_read_b128 v[44:47], v4 offset:49264
  s_waitcnt lgkmcnt(4)
  v_pk_add_f32 v[16:17], v[16:17], v[24:25]
  v_pk_add_f32 v[18:19], v[18:19], v[26:27]
  v_pk_add_f32 v[20:21], v[20:21], v[28:29]
  v_pk_add_f32 v[22:23], v[22:23], v[30:31]
  s_waitcnt lgkmcnt(0)
  v_pk_add_f32 v[32:33], v[32:33], v[40:41]
  v_pk_add_f32 v[34:35], v[34:35], v[42:43]
  v_pk_add_f32 v[36:37], v[36:37], v[44:45]
  v_pk_add_f32 v[38:39], v[38:39], v[46:47]
  v_pk_add_f32 v[16:17], v[16:17], v[32:33]
  v_pk_add_f32 v[18:19], v[18:19], v[34:35]
  v_pk_add_f32 v[20:21], v[20:21], v[36:37]
  v_pk_add_f32 v[22:23], v[22:23], v[38:39]
  v_cvt_pk_bf16_f32 v8, v16, v17
  v_cvt_pk_bf16_f32 v9, v18, v19
  v_cvt_pk_bf16_f32 v10, v20, v21
  v_cvt_pk_bf16_f32 v11, v22, v23
  buffer_store_dwordx4 v[8:11], v5, s[48:51], s34 offen
k3_end:
  s_endpgm
.section .rodata,"a"
.p2align 6
.amdhsa_kernel k1_kernel
  .amdhsa_next_free_vgpr 256
  .amdhsa_next_free_sgpr 100
  .amdhsa_accum_offset 128
  .amdhsa_group_segment_fixed_size 0
  .amdhsa_kernarg_size 112
  .amdhsa_user_sgpr_count 2
  .amdhsa_user_sgpr_kernarg_segment_ptr 1
  .amdhsa_system_sgpr_workgroup_id_x 1
.end_amdhsa_kernel
.p2align 6
.amdhsa_kernel k3_kernel
  .amdhsa_next_free_vgpr 256
  .amdhsa_next_free_sgpr 100
  .amdhsa_accum_offset 256
  .amdhsa_group_segment_fixed_size 0
  .amdhsa_kernarg_size 112
  .amdhsa_user_sgpr_count 2
  .amdhsa_user_sgpr_kernarg_segment_ptr 1
  .amdhsa_system_sgpr_workgroup_id_x 1
.end_amdhsa_kernel
```
